```python
import torch

def _softmax(x, axis=-1):
    return torch.softmax(x, dim=axis)
def _gelu(x):
    return torch.nn.functional.gelu(x, approximate="tanh")
def _silu(x):
    return torch.nn.functional.silu(x)
def _sigmoid(x):
    return torch.sigmoid(x)
def _layernorm(x, axis=-1, eps=1e-5):
    m = x.mean(dim=axis, keepdim=True)
    v = x.var(dim=axis, keepdim=True, unbiased=False)
    return (x - m) / torch.sqrt(v + eps)
def _scatter_add(tgt, idx, src, axis=0):
    return tgt.clone().index_add_(axis, idx, src)
def _segment_sum(src, seg, n):
    out = torch.zeros((n,) + src.shape[1:], dtype=src.dtype)
    return out.index_add_(0, seg, src)
def _pad(x, pw):
    flat = tuple(v for pair in reversed(pw) for v in pair)
    return torch.nn.functional.pad(x, flat)

kernel_name = 'concat_heads__ssm_conv_s4__grouped_kv_mqa__prompt'

def setup_inputs():

    _w = (lambda a: (lambda t: t.to(torch.bfloat16) if t.is_floating_point() else t)(torch.as_tensor(a)))
    def _A_setup():
        B, L, D, N = 1, 2048, 576, 128
        A_re = -(lambda _x: torch.exp(torch.as_tensor(_x)))((lambda *s: torch.randn(*s, dtype=torch.bfloat16) * 3.2)(D, N))
        A_im = torch.pi * (lambda *s: torch.randn(*s, dtype=torch.bfloat16) * 0.05)(D, N)
        B_re = (lambda *s: torch.randn(*s, dtype=torch.bfloat16) * 0.1)(D, N)
        B_im = (lambda *s: torch.randn(*s, dtype=torch.bfloat16) * 0.1)(D, N)
        C_re = (lambda *s: torch.randn(*s, dtype=torch.bfloat16) * 0.1)(D, N)
        C_im = (lambda *s: torch.randn(*s, dtype=torch.bfloat16) * 0.1)(D, N)
        log_dt = (lambda *s: torch.randn(*s, dtype=torch.bfloat16) * 0.05)(D) * 0.5 - 4.0
        Dskip = (lambda *s: torch.randn(*s, dtype=torch.bfloat16) * 0.05)(D)
        return {
            "u": _w((lambda *s: torch.randn(*s, dtype=torch.bfloat16) * 0.05)(B, L, D)),
            "A_re": _w(A_re),
            "A_im": _w(A_im),
            "B_re": _w(B_re),
            "B_im": _w(B_im),
            "C_re": _w(C_re),
            "C_im": _w(C_im),
            "log_dt": _w(log_dt),
            "Dskip": _w(Dskip),
        }
    _A_in = _A_setup()

    def _B_setup():
        B, S, D, H = 1, 2048, 576, 32
        Dh = D // H
        return {
            "x": _w((lambda *s: torch.randn(*s, dtype=torch.bfloat16) * 0.05)(B, S, D)),
            "wq": _w((lambda *s: torch.randn(*s, dtype=torch.bfloat16) * 0.8)(D, H * Dh)),
            "wk": _w((lambda *s: torch.randn(*s, dtype=torch.bfloat16) * 0.8)(D, Dh)),
            "wv": _w((lambda *s: torch.randn(*s, dtype=torch.bfloat16) * 0.05)(D, Dh)),
            "wo": _w((lambda *s: torch.randn(*s, dtype=torch.bfloat16) * 0.05)(H * Dh, D)),
        }
    _B_in = _B_setup()

    return {
        "A_u": _A_in["u"],
        "A_A_re": _A_in["A_re"],
        "A_A_im": _A_in["A_im"],
        "A_B_re": _A_in["B_re"],
        "A_B_im": _A_in["B_im"],
        "A_C_re": _A_in["C_re"],
        "A_C_im": _A_in["C_im"],
        "A_log_dt": _A_in["log_dt"],
        "A_Dskip": _A_in["Dskip"],
        "B_x": _B_in["x"],
        "B_wq": _B_in["wq"],
        "B_wk": _B_in["wk"],
        "B_wv": _B_in["wv"],
        "B_wo": _B_in["wo"],
    }

def reference(A_u, A_A_re, A_A_im, A_B_re, A_B_im, A_C_re, A_C_im, A_log_dt, A_Dskip, B_x, B_wq, B_wk, B_wv, B_wo):
    def _A_ref(u, A_re, A_im, B_re, B_im, C_re, C_im, log_dt, Dskip):
        Bsz, L, D = u.shape
        dt = torch.exp(log_dt)[:, None]
        A = A_re + 1j * A_im
        Bc = B_re + 1j * B_im
        Cc = C_re + 1j * C_im
        logdA = dt * A
        dB = dt * Bc
        l = (lambda x, dt: x.to(dt))(torch.arange(L), A_re.dtype)
        P = torch.exp(logdA[:, :, None] * l[None, None, :])
        K = torch.einsum("dn,dnl,dn->dl", Cc, P, dB).real
        L2 = 2 * L
        Kp = _pad(K, ((0, 0), (0, L)))
        up = (lambda x, *d: x.permute(*d))(u, 0, 2, 1)
        up = _pad(up, ((0, 0), (0, 0), (0, L)))
        Kf = (lambda x, axes=(-2,-1): torch.fft.rfft2(x.float(), dim=axes))(Kp[:, None, :], axes=(-2, -1))
        Uf = (lambda x, axes=(-2,-1): torch.fft.rfft2(x.float(), dim=axes))(up[:, :, None, :], axes=(-2, -1))
        Yf = Uf * Kf[None, :, :, :]
        y = (lambda x, s, axes=(-2,-1): torch.fft.irfft2(x, s=s, dim=axes).to(torch.bfloat16))(Yf, (1, L2), axes=(-2, -1))[:, :, 0, :L]
        y = (lambda x, *d: x.permute(*d))(y, 0, 2, 1) + u * Dskip[None, None, :]
        return y

    def _B_ref(x, wq, wk, wv, wo):
        B, S, D = x.shape
        H = 32
        Dh = D // H
        q = (lambda x, *d: x.permute(*d))((x @ wq).reshape(B, S, H, Dh), 0, 2, 1, 3)
        k = x @ wk
        v = x @ wv
        scores = torch.einsum("bhqd,bkd->bhqk", q, k) * (Dh ** -0.5)
        p = _softmax(scores, axis=-1)
        o = torch.einsum("bhqk,bkd->bhqd", p, v)
        return (lambda x, *d: x.permute(*d))(o, 0, 2, 1, 3).reshape(B, S, H * Dh) @ wo

    a = _A_ref(A_u, A_A_re, A_A_im, A_B_re, A_B_im, A_C_re, A_C_im, A_log_dt, A_Dskip)
    b = _B_ref(B_x, B_wq, B_wk, B_wv, B_wo)
    return torch.concatenate([a, b], axis=-1)
```

```asm
; @launch grid=(256,1,1) block=(768,1,1) lds=163840
.amdgcn_target "amdgcn-amd-amdhsa--gfx950"
.text
.globl concat_heads__ssm_conv_s4__grouped_kv_mqa__prompt_kernel
.type concat_heads__ssm_conv_s4__grouped_kv_mqa__prompt_kernel,@function
.p2align 8
concat_heads__ssm_conv_s4__grouped_kv_mqa__prompt_kernel:
    s_cmp_ge_u32 s2, 256
    s_cbranch_scc1 MAIN_END
    s_load_dwordx16 s[32:47], s[0:1], 64
    s_load_dwordx2 s[48:49], s[0:1], 128
    s_load_dwordx16 s[16:31], s[0:1], 0
    v_lshrrev_b32 v4, 6, v0
    v_and_b32 v1, 63, v0
    v_readfirstlane_b32 s76, v4
    v_mov_b32 v2, 0
    v_mov_b32 v3, 1
    s_and_b32 s77, s2, 7
    s_lshr_b32 s80, s2, 3
    s_and_b32 s80, s80, 3
    s_lshl_b32 s80, s80, 3
    s_add_u32 s77, s77, s80
    s_lshr_b32 s78, s2, 5
    s_cmp_ge_u32 s76, 8
    s_cbranch_scc1 M_HELP
    v_lshrrev_b32 v7, 3, v1
    s_and_b32 s80, s76, 1
    s_lshl_b32 s80, s80, 2
    v_lshrrev_b32 v4, 4, v1
    v_add_u32 v4, s80, v4
    v_and_b32 v5, 7, v1
    v_xor_b32 v4, v4, v5
    v_mul_u32_u24 v7, 1152, v7
    v_lshl_add_u32 v7, v4, 4, v7
    s_lshl_b32 s80, s77, 3
    s_add_u32 s80, s80, s76
    s_mul_i32 s80, s80, 9216
    s_lshl_b32 s81, s76, 10
    s_add_u32 s81, s81, 83200
    s_waitcnt lgkmcnt(0)
    s_mov_b32 s52, s34
    s_and_b32 s53, s35, 0xffff
    s_mov_b32 s54, 2359296
    s_mov_b32 s55, 0x00020000
DL_1:
    s_mov_b32 m0, s81
    s_add_u32 s81, s81, 8192
    buffer_load_dwordx4 v7, s[52:55], s80 offen  lds
    s_add_u32 s80, s80, 128
    s_cmp_lt_u32 s81, 156928
    s_cbranch_scc1 DL_1
    s_mov_b32 s68, s48
    s_and_b32 s69, s49, 0xffff
    s_mov_b32 s70, 8388608
    s_mov_b32 s71, 0x00020000
    s_barrier
    s_cmp_ge_u32 s78, 2
    s_cbranch_scc1 M_NOKV
    v_and_b32 v4, 15, v1
    v_lshrrev_b32 v5, 4, v1
    v_bfe_u32 v6, v1, 1, 3
    v_xor_b32 v6, v6, v5
    s_lshr_b32 s80, s76, 1
    s_lshl_b32 s80, s80, 11
    s_add_u32 s80, s80, 83200
    v_lshlrev_b32 v7, 7, v4
    v_add_u32 v7, s80, v7
    v_lshl_add_u32 v8, v6, 4, v7
    v_xor_b32 v6, 4, v6
    v_lshl_add_u32 v9, v6, 4, v7
    v_lshlrev_b32 v6, 3, v5
    v_bfe_u32 v7, v1, 2, 2
    v_lshl_add_u32 v6, v7, 1, v6
    v_mul_u32_u24 v6, 48, v6
    v_and_b32 v7, 3, v1
    v_lshl_add_u32 v6, v7, 3, v6
    s_and_b32 s80, s76, 1
    s_lshl_b32 s80, s80, 5
    s_add_u32 s80, s80, 55552
    v_add_u32 v10, s80, v6
    s_lshl_b32 s84, s77, 1
    s_lshr_b32 s85, s76, 2
    s_add_u32 s84, s84, s85
    s_lshr_b32 s85, s84, 3
    s_mul_i32 s85, s85, 20480
    s_add_u32 s85, s85, 2490368
    s_and_b32 s84, s84, 7
    s_bfe_u32 s86, s76, 0x10001
    s_waitcnt vmcnt(0)
    s_mov_b64 exec, 1
    ds_add_u32 v2, v3 offset:0
    s_mov_b64 exec, -1
    s_mov_b32 s99, 0x80000
W_2:
    ds_read_b32 v11, v2 offset:0
    s_waitcnt lgkmcnt(0)
    v_readfirstlane_b32 s80, v11
    s_cmp_ge_u32 s80, 11
    s_cbranch_scc1 WD_3
    s_sleep 1
    s_sub_u32 s99, s99, 1
    s_cmp_lg_u32 s99, 0
    s_cbranch_scc1 W_2
WD_3:
    s_cmp_eq_u32 s78, 1
    s_cbranch_scc1 M_VT
    ds_read_b64_tr_b16 v[16:17], v10 offset:0
    ds_read_b64_tr_b16 v[18:19], v10 offset:48
    ds_read_b128 v[20:23], v8 offset:0
    ds_read_b64_tr_b16 v[24:25], v10 offset:1536
    ds_read_b64_tr_b16 v[26:27], v10 offset:1584
    ds_read_b128 v[28:31], v9 offset:0
    ds_read_b64_tr_b16 v[32:33], v10 offset:3072
    ds_read_b64_tr_b16 v[34:35], v10 offset:3120
    ds_read_b128 v[36:39], v8 offset:8192
    ds_read_b64_tr_b16 v[40:41], v10 offset:4608
    ds_read_b64_tr_b16 v[42:43], v10 offset:4656
    ds_read_b128 v[44:47], v9 offset:8192
    ds_read_b64_tr_b16 v[48:49], v10 offset:6144
    ds_read_b64_tr_b16 v[50:51], v10 offset:6192
    ds_read_b128 v[52:55], v8 offset:16384
    s_waitcnt lgkmcnt(12)
    v_mfma_f32_16x16x32_bf16 v[64:67], v[16:19], v[20:23], 0
    ds_read_b64_tr_b16 v[56:57], v10 offset:7680
    ds_read_b64_tr_b16 v[58:59], v10 offset:7728
    ds_read_b128 v[60:63], v9 offset:16384
    s_waitcnt lgkmcnt(12)
    v_mfma_f32_16x16x32_bf16 v[64:67], v[24:27], v[28:31], v[64:67]
    ds_read_b64_tr_b16 v[16:17], v10 offset:9216
    ds_read_b64_tr_b16 v[18:19], v10 offset:9264
    ds_read_b128 v[20:23], v8 offset:24576
    s_waitcnt lgkmcnt(12)
    v_mfma_f32_16x16x32_bf16 v[64:67], v[32:35], v[36:39], v[64:67]
    ds_read_b64_tr_b16 v[24:25], v10 offset:10752
    ds_read_b64_tr_b16 v[26:27], v10 offset:10800
    ds_read_b128 v[28:31], v9 offset:24576
    s_waitcnt lgkmcnt(12)
    v_mfma_f32_16x16x32_bf16 v[64:67], v[40:43], v[44:47], v[64:67]
    ds_read_b64_tr_b16 v[32:33], v10 offset:12288
    ds_read_b64_tr_b16 v[34:35], v10 offset:12336
    ds_read_b128 v[36:39], v8 offset:32768
    s_waitcnt lgkmcnt(12)
    v_mfma_f32_16x16x32_bf16 v[64:67], v[48:51], v[52:55], v[64:67]
    ds_read_b64_tr_b16 v[40:41], v10 offset:13824
    ds_read_b64_tr_b16 v[42:43], v10 offset:13872
    ds_read_b128 v[44:47], v9 offset:32768
    s_waitcnt lgkmcnt(12)
    v_mfma_f32_16x16x32_bf16 v[64:67], v[56:59], v[60:63], v[64:67]
    ds_read_b64_tr_b16 v[48:49], v10 offset:15360
    ds_read_b64_tr_b16 v[50:51], v10 offset:15408
    ds_read_b128 v[52:55], v8 offset:40960
    s_waitcnt lgkmcnt(12)
    v_mfma_f32_16x16x32_bf16 v[64:67], v[16:19], v[20:23], v[64:67]
    ds_read_b64_tr_b16 v[56:57], v10 offset:16896
    ds_read_b64_tr_b16 v[58:59], v10 offset:16944
    ds_read_b128 v[60:63], v9 offset:40960
    s_waitcnt lgkmcnt(12)
    v_mfma_f32_16x16x32_bf16 v[64:67], v[24:27], v[28:31], v[64:67]
    ds_read_b64_tr_b16 v[16:17], v10 offset:18432
    ds_read_b64_tr_b16 v[18:19], v10 offset:18480
    ds_read_b128 v[20:23], v8 offset:49152
    s_waitcnt lgkmcnt(12)
    v_mfma_f32_16x16x32_bf16 v[64:67], v[32:35], v[36:39], v[64:67]
    ds_read_b64_tr_b16 v[24:25], v10 offset:19968
    ds_read_b64_tr_b16 v[26:27], v10 offset:20016
    ds_read_b128 v[28:31], v9 offset:49152
    s_waitcnt lgkmcnt(12)
    v_mfma_f32_16x16x32_bf16 v[64:67], v[40:43], v[44:47], v[64:67]
    ds_read_b64_tr_b16 v[32:33], v10 offset:21504
    ds_read_b64_tr_b16 v[34:35], v10 offset:21552
    ds_read_b128 v[36:39], v8 offset:57344
    s_waitcnt lgkmcnt(12)
    v_mfma_f32_16x16x32_bf16 v[64:67], v[48:51], v[52:55], v[64:67]
    ds_read_b64_tr_b16 v[40:41], v10 offset:23040
    ds_read_b64_tr_b16 v[42:43], v10 offset:23088
    ds_read_b128 v[44:47], v9 offset:57344
    s_waitcnt lgkmcnt(12)
    v_mfma_f32_16x16x32_bf16 v[64:67], v[56:59], v[60:63], v[64:67]
    v_add_u32 v8, 8192, v8
    ds_read_b64_tr_b16 v[48:49], v10 offset:24576
    ds_read_b64_tr_b16 v[50:51], v10 offset:24624
    ds_read_b128 v[52:55], v8 offset:57344
    s_waitcnt lgkmcnt(12)
    v_mfma_f32_16x16x32_bf16 v[64:67], v[16:19], v[20:23], v[64:67]
    v_add_u32 v9, 8192, v9
    ds_read_b64_tr_b16 v[56:57], v10 offset:26112
    ds_read_b64_tr_b16 v[58:59], v10 offset:26160
    ds_read_b128 v[60:63], v9 offset:57344
    s_waitcnt lgkmcnt(12)
    v_mfma_f32_16x16x32_bf16 v[64:67], v[24:27], v[28:31], v[64:67]
    s_waitcnt lgkmcnt(9)
    v_mfma_f32_16x16x32_bf16 v[64:67], v[32:35], v[36:39], v[64:67]
    s_waitcnt lgkmcnt(6)
    v_mfma_f32_16x16x32_bf16 v[64:67], v[40:43], v[44:47], v[64:67]
    s_waitcnt lgkmcnt(3)
    v_mfma_f32_16x16x32_bf16 v[64:67], v[48:51], v[52:55], v[64:67]
    s_waitcnt lgkmcnt(0)
    v_mfma_f32_16x16x32_bf16 v[64:67], v[56:59], v[60:63], v[64:67]
    s_bitcmp1_b32 s76, 0
    s_cbranch_scc1 M_K2
    v_lshrrev_b32 v6, 1, v5
    v_lshlrev_b32 v6, 9, v6
    v_lshl_add_u32 v6, v4, 4, v6
    v_and_b32 v7, 1, v5
    v_lshl_add_u32 v11, v7, 3, v6
    s_lshl_b32 s80, s84, 10
    s_lshl_b32 s81, s86, 8
    s_add_u32 s80, s80, s81
    s_add_u32 s80, s80, s85
    v_cvt_pk_bf16_f32 v16, v64, v65
    v_cvt_pk_bf16_f32 v17, v66, v67
    buffer_store_dwordx2 v[16:17], v11, s[68:71], s80 offen sc1
    s_branch M_KVS
M_K2:
    v_lshlrev_b32 v11, 4, v4
    s_lshr_b32 s80, s84, 2
    s_lshl_b32 s80, s80, 10
    s_and_b32 s81, s84, 1
    s_lshl_b32 s81, s81, 9
    s_add_u32 s80, s80, s81
    s_and_b32 s81, s84, 2
    s_lshl_b32 s81, s81, 2
    s_add_u32 s80, s80, s81
    s_lshl_b32 s81, s86, 8
    s_add_u32 s80, s80, s81
    s_add_u32 s80, s80, s85
    s_add_u32 s80, s80, 8192
    v_cvt_pk_bf16_f32 v16, v64, v65
    v_mov_b32 v17, 0x3f803f80
    s_mov_b64 exec, 0xffff
    buffer_store_dwordx2 v[16:17], v11, s[68:71], s80 offen sc1
    s_mov_b64 exec, -1
    s_branch M_KVS
M_VT:
    ds_read_b64_tr_b16 v[16:17], v10 offset:0
    ds_read_b64_tr_b16 v[18:19], v10 offset:48
    ds_read_b128 v[20:23], v8 offset:0
    ds_read_b64_tr_b16 v[24:25], v10 offset:1536
    ds_read_b64_tr_b16 v[26:27], v10 offset:1584
    ds_read_b128 v[28:31], v9 offset:0
    ds_read_b64_tr_b16 v[32:33], v10 offset:3072
    ds_read_b64_tr_b16 v[34:35], v10 offset:3120
    ds_read_b128 v[36:39], v8 offset:8192
    ds_read_b64_tr_b16 v[40:41], v10 offset:4608
    ds_read_b64_tr_b16 v[42:43], v10 offset:4656
    ds_read_b128 v[44:47], v9 offset:8192
    ds_read_b64_tr_b16 v[48:49], v10 offset:6144
    ds_read_b64_tr_b16 v[50:51], v10 offset:6192
    ds_read_b128 v[52:55], v8 offset:16384
    s_waitcnt lgkmcnt(12)
    v_mfma_f32_16x16x32_bf16 v[64:67], v[20:23], v[16:19], 0
    ds_read_b64_tr_b16 v[56:57], v10 offset:7680
    ds_read_b64_tr_b16 v[58:59], v10 offset:7728
    ds_read_b128 v[60:63], v9 offset:16384
    s_waitcnt lgkmcnt(12)
    v_mfma_f32_16x16x32_bf16 v[64:67], v[28:31], v[24:27], v[64:67]
    ds_read_b64_tr_b16 v[16:17], v10 offset:9216
    ds_read_b64_tr_b16 v[18:19], v10 offset:9264
    ds_read_b128 v[20:23], v8 offset:24576
    s_waitcnt lgkmcnt(12)
    v_mfma_f32_16x16x32_bf16 v[64:67], v[36:39], v[32:35], v[64:67]
    ds_read_b64_tr_b16 v[24:25], v10 offset:10752
    ds_read_b64_tr_b16 v[26:27], v10 offset:10800
    ds_read_b128 v[28:31], v9 offset:24576
    s_waitcnt lgkmcnt(12)
    v_mfma_f32_16x16x32_bf16 v[64:67], v[44:47], v[40:43], v[64:67]
    ds_read_b64_tr_b16 v[32:33], v10 offset:12288
    ds_read_b64_tr_b16 v[34:35], v10 offset:12336
    ds_read_b128 v[36:39], v8 offset:32768
    s_waitcnt lgkmcnt(12)
    v_mfma_f32_16x16x32_bf16 v[64:67], v[52:55], v[48:51], v[64:67]
    ds_read_b64_tr_b16 v[40:41], v10 offset:13824
    ds_read_b64_tr_b16 v[42:43], v10 offset:13872
    ds_read_b128 v[44:47], v9 offset:32768
    s_waitcnt lgkmcnt(12)
    v_mfma_f32_16x16x32_bf16 v[64:67], v[60:63], v[56:59], v[64:67]
    ds_read_b64_tr_b16 v[48:49], v10 offset:15360
    ds_read_b64_tr_b16 v[50:51], v10 offset:15408
    ds_read_b128 v[52:55], v8 offset:40960
    s_waitcnt lgkmcnt(12)
    v_mfma_f32_16x16x32_bf16 v[64:67], v[20:23], v[16:19], v[64:67]
    ds_read_b64_tr_b16 v[56:57], v10 offset:16896
    ds_read_b64_tr_b16 v[58:59], v10 offset:16944
    ds_read_b128 v[60:63], v9 offset:40960
    s_waitcnt lgkmcnt(12)
    v_mfma_f32_16x16x32_bf16 v[64:67], v[28:31], v[24:27], v[64:67]
    ds_read_b64_tr_b16 v[16:17], v10 offset:18432
    ds_read_b64_tr_b16 v[18:19], v10 offset:18480
    ds_read_b128 v[20:23], v8 offset:49152
    s_waitcnt lgkmcnt(12)
    v_mfma_f32_16x16x32_bf16 v[64:67], v[36:39], v[32:35], v[64:67]
    ds_read_b64_tr_b16 v[24:25], v10 offset:19968
    ds_read_b64_tr_b16 v[26:27], v10 offset:20016
    ds_read_b128 v[28:31], v9 offset:49152
    s_waitcnt lgkmcnt(12)
    v_mfma_f32_16x16x32_bf16 v[64:67], v[44:47], v[40:43], v[64:67]
    ds_read_b64_tr_b16 v[32:33], v10 offset:21504
    ds_read_b64_tr_b16 v[34:35], v10 offset:21552
    ds_read_b128 v[36:39], v8 offset:57344
    s_waitcnt lgkmcnt(12)
    v_mfma_f32_16x16x32_bf16 v[64:67], v[52:55], v[48:51], v[64:67]
    ds_read_b64_tr_b16 v[40:41], v10 offset:23040
    ds_read_b64_tr_b16 v[42:43], v10 offset:23088
    ds_read_b128 v[44:47], v9 offset:57344
    s_waitcnt lgkmcnt(12)
    v_mfma_f32_16x16x32_bf16 v[64:67], v[60:63], v[56:59], v[64:67]
    v_add_u32 v8, 8192, v8
    ds_read_b64_tr_b16 v[48:49], v10 offset:24576
    ds_read_b64_tr_b16 v[50:51], v10 offset:24624
    ds_read_b128 v[52:55], v8 offset:57344
    s_waitcnt lgkmcnt(12)
    v_mfma_f32_16x16x32_bf16 v[64:67], v[20:23], v[16:19], v[64:67]
    v_add_u32 v9, 8192, v9
    ds_read_b64_tr_b16 v[56:57], v10 offset:26112
    ds_read_b64_tr_b16 v[58:59], v10 offset:26160
    ds_read_b128 v[60:63], v9 offset:57344
    s_waitcnt lgkmcnt(12)
    v_mfma_f32_16x16x32_bf16 v[64:67], v[28:31], v[24:27], v[64:67]
    s_waitcnt lgkmcnt(9)
    v_mfma_f32_16x16x32_bf16 v[64:67], v[36:39], v[32:35], v[64:67]
    s_waitcnt lgkmcnt(6)
    v_mfma_f32_16x16x32_bf16 v[64:67], v[44:47], v[40:43], v[64:67]
    s_waitcnt lgkmcnt(3)
    v_mfma_f32_16x16x32_bf16 v[64:67], v[52:55], v[48:51], v[64:67]
    s_waitcnt lgkmcnt(0)
    v_mfma_f32_16x16x32_bf16 v[64:67], v[60:63], v[56:59], v[64:67]
    s_and_b32 s80, s76, 1
    s_lshl_b32 s80, s80, 4
    v_add_u32 v4, s80, v4
    v_subrev_u32 v6, 10, v4
    v_add_u32 v7, 2, v4
    v_cmp_gt_u32 vcc, 18, v4
    s_nop 1
    v_cndmask_b32 v6, v6, v7, vcc
    v_subrev_u32 v7, 8, v4
    v_cmp_gt_u32 vcc, 16, v4
    s_nop 1
    v_cndmask_b32 v6, v6, v7, vcc
    v_add_u32 v7, 6, v4
    v_cmp_gt_u32 vcc, 12, v4
    s_nop 1
    v_cndmask_b32 v6, v6, v7, vcc
    v_cmp_gt_u32 vcc, 4, v4
    s_nop 1
    v_cndmask_b32 v6, v6, v4, vcc
    v_and_b32 v7, 1, v5
    v_mul_u32_u24 v7, 320, v7
    v_lshl_add_u32 v6, v6, 4, v7
    v_lshrrev_b32 v7, 1, v5
    v_lshl_add_u32 v11, v7, 3, v6
    s_mul_i32 s80, s84, 1280
    s_mul_i32 s81, s86, 640
    s_add_u32 s80, s80, s81
    s_add_u32 s80, s80, s85
    s_add_u32 s80, s80, 10240
    v_cvt_pk_bf16_f32 v16, v64, v65
    v_cvt_pk_bf16_f32 v17, v66, v67
    v_mov_b32 v7, 0x3f803f80
    v_cmp_eq_u32 vcc, 18, v4
    s_nop 1
    v_cndmask_b32 v16, v16, v7, vcc
    v_cndmask_b32 v17, v17, v7, vcc
    v_cmp_eq_u32 vcc, 19, v4
    s_nop 1
    v_cndmask_b32 v16, v16, v2, vcc
    v_cndmask_b32 v17, v17, v2, vcc
    v_cmp_gt_u32 vcc, 20, v4
    s_and_b64 exec, exec, vcc
    buffer_store_dwordx2 v[16:17], v11, s[68:71], s80 offen sc1
    s_mov_b64 exec, -1
M_KVS:
    s_waitcnt vmcnt(0)
    s_mov_b64 exec, 1
    ds_add_u32 v2, v3 offset:8
    s_mov_b64 exec, -1
    s_branch M_QP
M_NOKV:
    s_waitcnt vmcnt(0)
    s_mov_b64 exec, 1
    ds_add_u32 v2, v3 offset:0
    s_mov_b64 exec, -1
M_QP:
    s_and_b32 s80, s76, 3
    s_mul_i32 s92, s80, 36
    s_and_b32 s80, s80, 1
    s_lshl_b32 s81, s80, 2
    s_sub_u32 s92, s92, s81
    s_mov_b32 s93, 1145188640
    s_cmp_eq_u32 s80, 0
    s_cselect_b32 s93, 4469024, s93
    v_and_b32 v4, 31, v1
    v_bfe_u32 v5, v1, 1, 3
    v_lshrrev_b32 v6, 5, v1
    v_xor_b32 v5, v5, v6
    s_lshr_b32 s80, s76, 2
    s_lshl_b32 s80, s80, 12
    s_add_u32 s80, s80, 83200
    v_lshlrev_b32 v4, 7, v4
    v_add_u32 v4, s80, v4
    v_xor_b32 v7, 0, v5
    v_lshl_add_u32 v10, v7, 4, v4
    v_xor_b32 v7, 2, v5
    v_lshl_add_u32 v11, v7, 4, v4
    v_xor_b32 v7, 4, v5
    v_lshl_add_u32 v12, v7, 4, v4
    v_xor_b32 v7, 6, v5
    v_lshl_add_u32 v13, v7, 4, v4
    v_lshlrev_b32 v4, 1, v6
    v_bfe_u32 v5, v1, 2, 2
    v_lshl_add_u32 v4, v5, 2, v4
    v_mul_u32_u24 v4, 144, v4
    v_bfe_u32 v5, v1, 4, 1
    v_and_b32 v6, 3, v1
    v_lshl_add_u32 v5, v5, 2, v6
    v_lshlrev_b32 v5, 2, v5
    v_lshrrev_b32 v5, v5, s93
    v_and_b32 v5, 7, v5
    v_lshl_add_u32 v4, v5, 3, v4
    s_add_u32 s80, s92, 256
    v_add_u32 v8, s80, v4
    s_mov_b32 s99, 0x80000
W_4:
    ds_read_b32 v4, v2 offset:0
    s_waitcnt lgkmcnt(0)
    v_readfirstlane_b32 s80, v4
    s_cmp_ge_u32 s80, 8
    s_cbranch_scc1 WD_5
    s_sleep 1
    s_sub_u32 s99, s99, 1
    s_cmp_lg_u32 s99, 0
    s_cbranch_scc1 W_4
WD_5:
    s_mov_b32 s99, 0x80000
W_6:
    ds_read_b32 v4, v2 offset:112
    s_waitcnt lgkmcnt(0)
    v_readfirstlane_b32 s80, v4
    s_cmp_ge_u32 s80, 3
    s_cbranch_scc1 WD_7
    s_sleep 1
    s_sub_u32 s99, s99, 1
    s_cmp_lg_u32 s99, 0
    s_cbranch_scc1 W_6
WD_7:
    ds_read_b64_tr_b16 v[16:17], v8 offset:0
    ds_read_b64_tr_b16 v[18:19], v8 offset:144
    ds_read_b128 v[20:23], v10 offset:0
    ds_read_b64_tr_b16 v[24:25], v8 offset:2304
    ds_read_b64_tr_b16 v[26:27], v8 offset:2448
    ds_read_b128 v[28:31], v11 offset:0
    ds_read_b64_tr_b16 v[32:33], v8 offset:4608
    ds_read_b64_tr_b16 v[34:35], v8 offset:4752
    ds_read_b128 v[36:39], v12 offset:0
    ds_read_b64_tr_b16 v[40:41], v8 offset:6912
    ds_read_b64_tr_b16 v[42:43], v8 offset:7056
    ds_read_b128 v[44:47], v13 offset:0
    ds_read_b64_tr_b16 v[48:49], v8 offset:9216
    ds_read_b64_tr_b16 v[50:51], v8 offset:9360
    ds_read_b128 v[52:55], v10 offset:8192
    s_waitcnt lgkmcnt(12)
    v_mfma_f32_32x32x16_bf16 v[132:147], v[16:19], v[20:23], 0
    ds_read_b64_tr_b16 v[56:57], v8 offset:11520
    ds_read_b64_tr_b16 v[58:59], v8 offset:11664
    ds_read_b128 v[60:63], v11 offset:8192
    s_waitcnt lgkmcnt(12)
    v_mfma_f32_32x32x16_bf16 v[132:147], v[24:27], v[28:31], v[132:147]
    ds_read_b64_tr_b16 v[16:17], v8 offset:13824
    ds_read_b64_tr_b16 v[18:19], v8 offset:13968
    ds_read_b128 v[20:23], v12 offset:8192
    s_waitcnt lgkmcnt(12)
    v_mfma_f32_32x32x16_bf16 v[132:147], v[32:35], v[36:39], v[132:147]
    ds_read_b64_tr_b16 v[24:25], v8 offset:16128
    ds_read_b64_tr_b16 v[26:27], v8 offset:16272
    ds_read_b128 v[28:31], v13 offset:8192
    s_waitcnt lgkmcnt(12)
    v_mfma_f32_32x32x16_bf16 v[132:147], v[40:43], v[44:47], v[132:147]
    ds_read_b64_tr_b16 v[32:33], v8 offset:18432
    ds_read_b64_tr_b16 v[34:35], v8 offset:18576
    ds_read_b128 v[36:39], v10 offset:16384
    s_waitcnt lgkmcnt(12)
    v_mfma_f32_32x32x16_bf16 v[132:147], v[48:51], v[52:55], v[132:147]
    ds_read_b64_tr_b16 v[40:41], v8 offset:20736
    ds_read_b64_tr_b16 v[42:43], v8 offset:20880
    ds_read_b128 v[44:47], v11 offset:16384
    s_waitcnt lgkmcnt(12)
    v_mfma_f32_32x32x16_bf16 v[132:147], v[56:59], v[60:63], v[132:147]
    ds_read_b64_tr_b16 v[48:49], v8 offset:23040
    ds_read_b64_tr_b16 v[50:51], v8 offset:23184
    ds_read_b128 v[52:55], v12 offset:16384
    s_waitcnt lgkmcnt(12)
    v_mfma_f32_32x32x16_bf16 v[132:147], v[16:19], v[20:23], v[132:147]
    ds_read_b64_tr_b16 v[56:57], v8 offset:25344
    ds_read_b64_tr_b16 v[58:59], v8 offset:25488
    ds_read_b128 v[60:63], v13 offset:16384
    s_waitcnt lgkmcnt(12)
    v_mfma_f32_32x32x16_bf16 v[132:147], v[24:27], v[28:31], v[132:147]
    s_waitcnt lgkmcnt(9)
    v_mfma_f32_32x32x16_bf16 v[132:147], v[32:35], v[36:39], v[132:147]
    s_waitcnt lgkmcnt(6)
    v_mfma_f32_32x32x16_bf16 v[132:147], v[40:43], v[44:47], v[132:147]
    s_waitcnt lgkmcnt(3)
    v_mfma_f32_32x32x16_bf16 v[132:147], v[48:51], v[52:55], v[132:147]
    s_waitcnt lgkmcnt(0)
    v_mfma_f32_32x32x16_bf16 v[132:147], v[56:59], v[60:63], v[132:147]
    v_add_u32 v8, 27648, v8
    v_add_u32 v10, 24576, v10
    v_add_u32 v11, 24576, v11
    v_add_u32 v12, 24576, v12
    v_add_u32 v13, 24576, v13
    s_mov_b64 exec, 1
    ds_add_u32 v2, v3 offset:24
    s_mov_b64 exec, -1
    s_mov_b32 s99, 0x80000
W_8:
    ds_read_b32 v4, v2 offset:116
    s_waitcnt lgkmcnt(0)
    v_readfirstlane_b32 s80, v4
    s_cmp_ge_u32 s80, 3
    s_cbranch_scc1 WD_9
    s_sleep 1
    s_sub_u32 s99, s99, 1
    s_cmp_lg_u32 s99, 0
    s_cbranch_scc1 W_8
WD_9:
    ds_read_b64_tr_b16 v[16:17], v8 offset:0
    ds_read_b64_tr_b16 v[18:19], v8 offset:144
    ds_read_b128 v[20:23], v10 offset:0
    ds_read_b64_tr_b16 v[24:25], v8 offset:2304
    ds_read_b64_tr_b16 v[26:27], v8 offset:2448
    ds_read_b128 v[28:31], v11 offset:0
    ds_read_b64_tr_b16 v[32:33], v8 offset:4608
    ds_read_b64_tr_b16 v[34:35], v8 offset:4752
    ds_read_b128 v[36:39], v12 offset:0
    ds_read_b64_tr_b16 v[40:41], v8 offset:6912
    ds_read_b64_tr_b16 v[42:43], v8 offset:7056
    ds_read_b128 v[44:47], v13 offset:0
    ds_read_b64_tr_b16 v[48:49], v8 offset:9216
    ds_read_b64_tr_b16 v[50:51], v8 offset:9360
    ds_read_b128 v[52:55], v10 offset:8192
    s_waitcnt lgkmcnt(12)
    v_mfma_f32_32x32x16_bf16 v[132:147], v[16:19], v[20:23], v[132:147]
    ds_read_b64_tr_b16 v[56:57], v8 offset:11520
    ds_read_b64_tr_b16 v[58:59], v8 offset:11664
    ds_read_b128 v[60:63], v11 offset:8192
    s_waitcnt lgkmcnt(12)
    v_mfma_f32_32x32x16_bf16 v[132:147], v[24:27], v[28:31], v[132:147]
    ds_read_b64_tr_b16 v[16:17], v8 offset:13824
    ds_read_b64_tr_b16 v[18:19], v8 offset:13968
    ds_read_b128 v[20:23], v12 offset:8192
    s_waitcnt lgkmcnt(12)
    v_mfma_f32_32x32x16_bf16 v[132:147], v[32:35], v[36:39], v[132:147]
    ds_read_b64_tr_b16 v[24:25], v8 offset:16128
    ds_read_b64_tr_b16 v[26:27], v8 offset:16272
    ds_read_b128 v[28:31], v13 offset:8192
    s_waitcnt lgkmcnt(12)
    v_mfma_f32_32x32x16_bf16 v[132:147], v[40:43], v[44:47], v[132:147]
    ds_read_b64_tr_b16 v[32:33], v8 offset:18432
    ds_read_b64_tr_b16 v[34:35], v8 offset:18576
    ds_read_b128 v[36:39], v10 offset:16384
    s_waitcnt lgkmcnt(12)
    v_mfma_f32_32x32x16_bf16 v[132:147], v[48:51], v[52:55], v[132:147]
    ds_read_b64_tr_b16 v[40:41], v8 offset:20736
    ds_read_b64_tr_b16 v[42:43], v8 offset:20880
    ds_read_b128 v[44:47], v11 offset:16384
    s_waitcnt lgkmcnt(12)
    v_mfma_f32_32x32x16_bf16 v[132:147], v[56:59], v[60:63], v[132:147]
    ds_read_b64_tr_b16 v[48:49], v8 offset:23040
    ds_read_b64_tr_b16 v[50:51], v8 offset:23184
    ds_read_b128 v[52:55], v12 offset:16384
    s_waitcnt lgkmcnt(12)
    v_mfma_f32_32x32x16_bf16 v[132:147], v[16:19], v[20:23], v[132:147]
    ds_read_b64_tr_b16 v[56:57], v8 offset:25344
    ds_read_b64_tr_b16 v[58:59], v8 offset:25488
    ds_read_b128 v[60:63], v13 offset:16384
    s_waitcnt lgkmcnt(12)
    v_mfma_f32_32x32x16_bf16 v[132:147], v[24:27], v[28:31], v[132:147]
    s_waitcnt lgkmcnt(9)
    v_mfma_f32_32x32x16_bf16 v[132:147], v[32:35], v[36:39], v[132:147]
    s_waitcnt lgkmcnt(6)
    v_mfma_f32_32x32x16_bf16 v[132:147], v[40:43], v[44:47], v[132:147]
    s_waitcnt lgkmcnt(3)
    v_mfma_f32_32x32x16_bf16 v[132:147], v[48:51], v[52:55], v[132:147]
    s_waitcnt lgkmcnt(0)
    v_mfma_f32_32x32x16_bf16 v[132:147], v[56:59], v[60:63], v[132:147]
    v_add_u32 v8, 27648, v8
    v_add_u32 v10, 24576, v10
    v_add_u32 v11, 24576, v11
    v_add_u32 v12, 24576, v12
    v_add_u32 v13, 24576, v13
    s_mov_b32 s99, 0x80000
W_10:
    ds_read_b32 v4, v2 offset:120
    s_waitcnt lgkmcnt(0)
    v_readfirstlane_b32 s80, v4
    s_cmp_ge_u32 s80, 3
    s_cbranch_scc1 WD_11
    s_sleep 1
    s_sub_u32 s99, s99, 1
    s_cmp_lg_u32 s99, 0
    s_cbranch_scc1 W_10
WD_11:
    ds_read_b64_tr_b16 v[16:17], v8 offset:0
    ds_read_b64_tr_b16 v[18:19], v8 offset:144
    ds_read_b128 v[20:23], v10 offset:0
    ds_read_b64_tr_b16 v[24:25], v8 offset:2304
    ds_read_b64_tr_b16 v[26:27], v8 offset:2448
    ds_read_b128 v[28:31], v11 offset:0
    ds_read_b64_tr_b16 v[32:33], v8 offset:4608
    ds_read_b64_tr_b16 v[34:35], v8 offset:4752
    ds_read_b128 v[36:39], v12 offset:0
    ds_read_b64_tr_b16 v[40:41], v8 offset:6912
    ds_read_b64_tr_b16 v[42:43], v8 offset:7056
    ds_read_b128 v[44:47], v13 offset:0
    ds_read_b64_tr_b16 v[48:49], v8 offset:9216
    ds_read_b64_tr_b16 v[50:51], v8 offset:9360
    ds_read_b128 v[52:55], v10 offset:8192
    s_waitcnt lgkmcnt(12)
    v_mfma_f32_32x32x16_bf16 v[132:147], v[16:19], v[20:23], v[132:147]
    ds_read_b64_tr_b16 v[56:57], v8 offset:11520
    ds_read_b64_tr_b16 v[58:59], v8 offset:11664
    ds_read_b128 v[60:63], v11 offset:8192
    s_waitcnt lgkmcnt(12)
    v_mfma_f32_32x32x16_bf16 v[132:147], v[24:27], v[28:31], v[132:147]
    ds_read_b64_tr_b16 v[16:17], v8 offset:13824
    ds_read_b64_tr_b16 v[18:19], v8 offset:13968
    ds_read_b128 v[20:23], v12 offset:8192
    s_waitcnt lgkmcnt(12)
    v_mfma_f32_32x32x16_bf16 v[132:147], v[32:35], v[36:39], v[132:147]
    ds_read_b64_tr_b16 v[24:25], v8 offset:16128
    ds_read_b64_tr_b16 v[26:27], v8 offset:16272
    ds_read_b128 v[28:31], v13 offset:8192
    s_waitcnt lgkmcnt(12)
    v_mfma_f32_32x32x16_bf16 v[132:147], v[40:43], v[44:47], v[132:147]
    ds_read_b64_tr_b16 v[32:33], v8 offset:18432
    ds_read_b64_tr_b16 v[34:35], v8 offset:18576
    ds_read_b128 v[36:39], v10 offset:16384
    s_waitcnt lgkmcnt(12)
    v_mfma_f32_32x32x16_bf16 v[132:147], v[48:51], v[52:55], v[132:147]
    ds_read_b64_tr_b16 v[40:41], v8 offset:20736
    ds_read_b64_tr_b16 v[42:43], v8 offset:20880
    ds_read_b128 v[44:47], v11 offset:16384
    s_waitcnt lgkmcnt(12)
    v_mfma_f32_32x32x16_bf16 v[132:147], v[56:59], v[60:63], v[132:147]
    ds_read_b64_tr_b16 v[48:49], v8 offset:23040
    ds_read_b64_tr_b16 v[50:51], v8 offset:23184
    ds_read_b128 v[52:55], v12 offset:16384
    s_waitcnt lgkmcnt(12)
    v_mfma_f32_32x32x16_bf16 v[132:147], v[16:19], v[20:23], v[132:147]
    ds_read_b64_tr_b16 v[56:57], v8 offset:25344
    ds_read_b64_tr_b16 v[58:59], v8 offset:25488
    ds_read_b128 v[60:63], v13 offset:16384
    s_waitcnt lgkmcnt(12)
    v_mfma_f32_32x32x16_bf16 v[132:147], v[24:27], v[28:31], v[132:147]
    s_waitcnt lgkmcnt(9)
    v_mfma_f32_32x32x16_bf16 v[132:147], v[32:35], v[36:39], v[132:147]
    s_waitcnt lgkmcnt(6)
    v_mfma_f32_32x32x16_bf16 v[132:147], v[40:43], v[44:47], v[132:147]
    s_waitcnt lgkmcnt(3)
    v_mfma_f32_32x32x16_bf16 v[132:147], v[48:51], v[52:55], v[132:147]
    s_waitcnt lgkmcnt(0)
    v_mfma_f32_32x32x16_bf16 v[132:147], v[56:59], v[60:63], v[132:147]
    s_mov_b64 exec, 1
    ds_add_u32 v2, v3 offset:12
    s_mov_b64 exec, -1
    v_and_b32 v5, 31, v1
    v_and_b32 v7, 27, v5
    v_cmp_eq_u32 vcc, 18, v7
    v_mov_b32 v6, 9
    v_add_u32 v7, 2, v5
    v_cndmask_b32 v6, v6, 8, vcc
    v_cmp_gt_u32 vcc, 18, v5
    s_nop 1
    v_cndmask_b32 v6, v6, v7, vcc
    v_subrev_u32 v4, 8, v5
    v_cmp_gt_u32 vcc, 16, v5
    s_nop 1
    v_cndmask_b32 v6, v6, v4, vcc
    v_cmp_gt_u32 vcc, 12, v5
    s_nop 1
    v_cndmask_b32 v6, v6, v7, vcc
    v_add_u32 v4, 10, v5
    v_cmp_gt_u32 vcc, 8, v5
    s_nop 1
    v_cndmask_b32 v6, v6, v4, vcc
    v_cmp_gt_u32 vcc, 4, v5
    s_nop 1
    v_cndmask_b32 v6, v6, v5, vcc
    v_lshrrev_b32 v7, 5, v1
    v_mul_u32_u24 v7, 320, v7
    v_lshl_add_u32 v122, v6, 4, v7
    v_add_u32 v118, 10496, v122
    v_add_u32 v119, 20480, v118
    v_lshlrev_b32 v116, 4, v1
    v_add_u32 v116, 256, v116
    v_add_u32 v117, 20480, v116
    v_mov_b32 v120, 0
    s_mov_b32 s80, 0x3eae1a93
    v_mul_f32 v132, s80, v132
    v_mul_f32 v133, s80, v133
    v_mul_f32 v134, s80, v134
    v_mul_f32 v135, s80, v135
    v_mul_f32 v136, s80, v136
    v_mul_f32 v137, s80, v137
    v_mul_f32 v138, s80, v138
    v_mul_f32 v139, s80, v139
    v_mul_f32 v140, s80, v140
    v_mul_f32 v141, s80, v141
    v_mul_f32 v142, s80, v142
    v_mul_f32 v143, s80, v143
    v_mul_f32 v144, s80, v144
    v_mul_f32 v145, s80, v145
    v_mul_f32 v146, s80, v146
    v_mul_f32 v147, s80, v147
    s_bitcmp1_b32 s76, 0
    s_cbranch_scc1 M_QODD
    v_cvt_pk_bf16_f32 v124, v132, v133
    v_cvt_pk_bf16_f32 v125, v134, v135
    v_cvt_pk_bf16_f32 v126, v136, v137
    v_cvt_pk_bf16_f32 v127, v138, v139
    v_cvt_pk_bf16_f32 v128, v140, v141
    s_branch M_QD
M_QODD:
    v_cvt_pk_bf16_f32 v124, v134, v135
    v_cvt_pk_bf16_f32 v125, v136, v137
    v_cvt_pk_bf16_f32 v126, v138, v139
    v_cvt_pk_bf16_f32 v127, v140, v141
    v_cvt_pk_bf16_f32 v128, v146, v147
M_QD:
    v_mov_b32 v129, 0
    v_mov_b32 v72, 0
    v_mov_b32 v73, 0
    v_mov_b32 v74, 0
    v_mov_b32 v75, 0
    v_mov_b32 v76, 0
    v_mov_b32 v77, 0
    v_mov_b32 v78, 0
    v_mov_b32 v79, 0
    v_mov_b32 v80, 0
    v_mov_b32 v81, 0
    v_mov_b32 v82, 0
    v_mov_b32 v83, 0
    v_mov_b32 v84, 0
    v_mov_b32 v85, 0
    v_mov_b32 v86, 0
    v_mov_b32 v87, 0
    v_mov_b32 v64, 0
    v_mov_b32 v112, 0
    v_mov_b32 v65, 0
    v_mov_b32 v113, 0
    v_mov_b32 v66, 0
    v_mov_b32 v114, 0
    v_mov_b32 v67, 0
    v_mov_b32 v115, 0
    s_mov_b32 s99, 0x80000
W_12:
    ds_read_b32 v4, v2 offset:16
    s_waitcnt lgkmcnt(0)
    v_readfirstlane_b32 s80, v4
    s_cmp_ge_u32 s80, 1
    s_cbranch_scc1 WD_13
    s_sleep 1
    s_sub_u32 s99, s99, 1
    s_cmp_lg_u32 s99, 0
    s_cbranch_scc1 W_12
WD_13:
    v_lshlrev_b32 v4, 4, v1
    s_lshl_b32 s80, s76, 10
    s_add_u32 s81, s80, 20480
    s_add_u32 m0, s81, 256
    s_add_u32 s81, s81, 2510848
    buffer_load_dwordx4 v4, s[68:71], s81 offen sc1 lds
    s_add_u32 s81, s80, 28672
    s_add_u32 m0, s81, 256
    s_add_u32 s81, s81, 2510848
    buffer_load_dwordx4 v4, s[68:71], s81 offen sc1 lds
    s_min_u32 s81, s80, 3072
    s_add_u32 s81, s81, 36864
    s_add_u32 m0, s81, 256
    s_add_u32 s81, s81, 2510848
    buffer_load_dwordx4 v4, s[68:71], s81 offen sc1 lds
    s_add_u32 s81, s80, 40960
    s_add_u32 m0, s81, 256
    s_add_u32 s81, s81, 2531328
    buffer_load_dwordx4 v4, s[68:71], s81 offen sc1 lds
    s_add_u32 s81, s80, 49152
    s_add_u32 m0, s81, 256
    s_add_u32 s81, s81, 2531328
    buffer_load_dwordx4 v4, s[68:71], s81 offen sc1 lds
    s_min_u32 s81, s80, 3072
    s_add_u32 s81, s81, 57344
    s_add_u32 m0, s81, 256
    s_add_u32 s81, s81, 2531328
    buffer_load_dwordx4 v4, s[68:71], s81 offen sc1 lds
    s_mov_b32 s99, 0x80000
W_14:
    ds_read_b32 v4, v2 offset:32
    s_waitcnt lgkmcnt(0)
    v_readfirstlane_b32 s80, v4
    s_cmp_ge_u32 s80, 8
    s_cbranch_scc1 WD_15
    s_sleep 1
    s_sub_u32 s99, s99, 1
    s_cmp_lg_u32 s99, 0
    s_cbranch_scc1 W_14
WD_15:
    ds_read_b128 v[88:91], v116 offset:0
    ds_read_b128 v[92:95], v116 offset:1024
    ds_read_b128 v[96:99], v116 offset:8192
    ds_read_b128 v[100:103], v118 offset:0
    ds_read_b128 v[104:107], v118 offset:640
    ds_read_b128 v[108:111], v118 offset:1280
    s_waitcnt lgkmcnt(3)
    v_mfma_f32_32x32x16_bf16 v[8:23], v[88:91], v[124:127], 0
    v_mfma_f32_32x32x16_bf16 v[24:39], v[92:95], v[124:127], 0
    s_nop 9
    v_mfma_f32_32x32x4_2b_bf16 v[8:39], v[96:97], v[128:129], v[8:39]
    s_nop 15
    s_nop 4
    v_max3_f32 v40, v8, v9, v10
    v_max3_f32 v41, v11, v12, v13
    v_max3_f32 v42, v14, v15, v16
    v_max3_f32 v43, v17, v18, v19
    v_max3_f32 v44, v20, v21, v22
    v_max3_f32 v45, v23, v24, v25
    v_max3_f32 v46, v26, v27, v28
    v_max3_f32 v47, v29, v30, v31
    v_max3_f32 v48, v32, v33, v34
    v_max3_f32 v49, v35, v36, v37
    v_max3_f32 v40, v40, v38, v39
    v_max3_f32 v40, v40, v41, v42
    v_max3_f32 v43, v43, v44, v45
    v_max3_f32 v46, v46, v47, v48
    v_max3_f32 v40, v40, v43, v46
    v_max_f32 v40, v40, v49
    v_mov_b32 v41, v40
    s_nop 1
    v_permlane32_swap_b32 v40, v41
    s_nop 1
    v_max_f32 v40, v40, v41
    v_cvt_pk_bf16_f32 v129, -v40, 0
    s_nop 1
    v_mfma_f32_32x32x16_bf16 v[8:23], v[88:91], v[124:127], 0
    v_mfma_f32_32x32x16_bf16 v[24:39], v[92:95], v[124:127], 0
    ds_read_b128 v[88:91], v116 offset:2048
    ds_read_b128 v[92:95], v116 offset:3072
    s_nop 7
    v_mfma_f32_32x32x4_2b_bf16 v[8:39], v[96:97], v[128:129], v[8:39]
    s_waitcnt vmcnt(3)
    s_mov_b64 exec, 1
    ds_add_u32 v2, v3 offset:36
    s_mov_b64 exec, -1
    s_waitcnt vmcnt(0)
    s_mov_b64 exec, 1
    ds_add_u32 v2, v3 offset:40
    s_mov_b64 exec, -1
    s_mov_b32 s90, 0
    s_waitcnt lgkmcnt(0)
    s_nop 15
    s_nop 3
A_LOOP:
    s_waitcnt lgkmcnt(2)
    s_setprio 1
    s_mov_b64 exec, 1
    ds_add_u32 v120, v3 offset:68
    s_mov_b64 exec, -1
    v_mfma_f32_32x32x16_bf16 v[40:55], v[88:91], v[124:127], 0
    ds_read_b128 v[88:91], v116 offset:4096
    v_exp_f32 v8, v8
    v_exp_f32 v9, v9
    v_exp_f32 v10, v10
    v_exp_f32 v11, v11
    v_mfma_f32_32x32x16_bf16 v[72:87], v[112:115], v[64:67], v[72:87]
    ds_read_b128 v[112:115], v118 offset:1920
    v_exp_f32 v12, v12
    v_exp_f32 v13, v13
    v_exp_f32 v14, v14
    v_exp_f32 v15, v15
    v_mfma_f32_32x32x16_bf16 v[56:71], v[92:95], v[124:127], 0
    ds_read_b128 v[92:95], v116 offset:5120
    v_cvt_pk_bf16_f32 v8, v8, v9
    v_cvt_pk_bf16_f32 v9, v10, v11
    v_cvt_pk_bf16_f32 v10, v12, v13
    v_cvt_pk_bf16_f32 v11, v14, v15
    v_exp_f32 v16, v16
    v_exp_f32 v17, v17
    v_exp_f32 v18, v18
    v_exp_f32 v19, v19
    v_mfma_f32_32x32x16_bf16 v[72:87], v[100:103], v[8:11], v[72:87]
    ds_read_b128 v[100:103], v118 offset:2560
    v_exp_f32 v20, v20
    v_exp_f32 v21, v21
    v_exp_f32 v22, v22
    v_exp_f32 v23, v23
    v_cvt_pk_bf16_f32 v16, v16, v17
    v_cvt_pk_bf16_f32 v17, v18, v19
    v_cvt_pk_bf16_f32 v18, v20, v21
    v_cvt_pk_bf16_f32 v19, v22, v23
    v_mfma_f32_32x32x4_2b_bf16 v[40:71], v[98:99], v[128:129], v[40:71]
    ds_read_b128 v[96:99], v116 offset:9216
    v_exp_f32 v24, v24
    v_exp_f32 v25, v25
    v_exp_f32 v26, v26
    v_exp_f32 v27, v27
    v_exp_f32 v28, v28
    v_exp_f32 v29, v29
    v_exp_f32 v30, v30
    v_exp_f32 v31, v31
    s_waitcnt lgkmcnt(4)
    v_mfma_f32_32x32x16_bf16 v[72:87], v[104:107], v[16:19], v[72:87]
    ds_read_b128 v[104:107], v118 offset:3200
    v_cvt_pk_bf16_f32 v24, v24, v25
    v_cvt_pk_bf16_f32 v25, v26, v27
    v_cvt_pk_bf16_f32 v26, v28, v29
    v_cvt_pk_bf16_f32 v27, v30, v31
    v_exp_f32 v32, v32
    v_exp_f32 v33, v33
    v_exp_f32 v34, v34
    v_exp_f32 v35, v35
    v_mfma_f32_32x32x16_bf16 v[72:87], v[108:111], v[24:27], v[72:87]
    ds_read_b128 v[108:111], v118 offset:3840
    v_exp_f32 v36, v36
    v_exp_f32 v37, v37
    v_exp_f32 v38, v38
    v_exp_f32 v39, v39
    v_cvt_pk_bf16_f32 v32, v32, v33
    v_cvt_pk_bf16_f32 v33, v34, v35
    v_cvt_pk_bf16_f32 v34, v36, v37
    v_cvt_pk_bf16_f32 v35, v38, v39
    s_waitcnt lgkmcnt(2)
    ds_read_b32 v121, v120 offset:36
    v_mfma_f32_32x32x16_bf16 v[8:23], v[88:91], v[124:127], 0
    ds_read_b128 v[88:91], v116 offset:6144
    v_exp_f32 v40, v40
    v_exp_f32 v41, v41
    v_exp_f32 v42, v42
    v_exp_f32 v43, v43
    v_mfma_f32_32x32x16_bf16 v[72:87], v[112:115], v[32:35], v[72:87]
    ds_read_b128 v[112:115], v118 offset:4480
    v_exp_f32 v44, v44
    v_exp_f32 v45, v45
    v_exp_f32 v46, v46
    v_exp_f32 v47, v47
    v_mfma_f32_32x32x16_bf16 v[24:39], v[92:95], v[124:127], 0
    ds_read_b128 v[92:95], v116 offset:7168
    v_cvt_pk_bf16_f32 v40, v40, v41
    v_cvt_pk_bf16_f32 v41, v42, v43
    v_cvt_pk_bf16_f32 v42, v44, v45
    v_cvt_pk_bf16_f32 v43, v46, v47
    v_exp_f32 v48, v48
    v_exp_f32 v49, v49
    v_exp_f32 v50, v50
    v_exp_f32 v51, v51
    v_mfma_f32_32x32x16_bf16 v[72:87], v[100:103], v[40:43], v[72:87]
    ds_read_b128 v[100:103], v118 offset:5120
    v_exp_f32 v52, v52
    v_exp_f32 v53, v53
    v_exp_f32 v54, v54
    v_exp_f32 v55, v55
    v_cvt_pk_bf16_f32 v48, v48, v49
    v_cvt_pk_bf16_f32 v49, v50, v51
    v_cvt_pk_bf16_f32 v50, v52, v53
    v_cvt_pk_bf16_f32 v51, v54, v55
    v_mfma_f32_32x32x4_2b_bf16 v[8:39], v[96:97], v[128:129], v[8:39]
    v_exp_f32 v56, v56
    v_exp_f32 v57, v57
    v_exp_f32 v58, v58
    v_exp_f32 v59, v59
    v_exp_f32 v60, v60
    v_exp_f32 v61, v61
    v_exp_f32 v62, v62
    v_exp_f32 v63, v63
    s_waitcnt lgkmcnt(4)
    v_mfma_f32_32x32x16_bf16 v[72:87], v[104:107], v[48:51], v[72:87]
    ds_read_b128 v[104:107], v118 offset:5760
    v_cvt_pk_bf16_f32 v56, v56, v57
    v_cvt_pk_bf16_f32 v57, v58, v59
    v_cvt_pk_bf16_f32 v58, v60, v61
    v_cvt_pk_bf16_f32 v59, v62, v63
    v_exp_f32 v64, v64
    v_exp_f32 v65, v65
    v_exp_f32 v66, v66
    v_exp_f32 v67, v67
    v_mfma_f32_32x32x16_bf16 v[72:87], v[108:111], v[56:59], v[72:87]
    ds_read_b128 v[108:111], v118 offset:6400
    v_exp_f32 v68, v68
    v_exp_f32 v69, v69
    v_exp_f32 v70, v70
    v_exp_f32 v71, v71
    v_cvt_pk_bf16_f32 v64, v64, v65
    v_cvt_pk_bf16_f32 v65, v66, v67
    v_cvt_pk_bf16_f32 v66, v68, v69
    v_cvt_pk_bf16_f32 v67, v70, v71
    s_waitcnt lgkmcnt(2)
    s_setprio 0
    v_readfirstlane_b32 s80, v121
    s_cmp_ge_u32 s80, 8
    s_cbranch_scc1 AOK_16
    s_mov_b32 s99, 0x80000
W_17:
    ds_read_b32 v121, v120 offset:36
    s_waitcnt lgkmcnt(0)
    v_readfirstlane_b32 s80, v121
    s_cmp_ge_u32 s80, 8
    s_cbranch_scc1 WD_18
    s_sleep 1
    s_sub_u32 s99, s99, 1
    s_cmp_lg_u32 s99, 0
    s_cbranch_scc1 W_17
WD_18:
AOK_16:
    v_mfma_f32_32x32x16_bf16 v[40:55], v[88:91], v[124:127], 0
    ds_read_b128 v[88:91], v117 offset:0
    v_exp_f32 v8, v8
    v_exp_f32 v9, v9
    v_exp_f32 v10, v10
    v_exp_f32 v11, v11
    v_mfma_f32_32x32x16_bf16 v[72:87], v[112:115], v[64:67], v[72:87]
    ds_read_b128 v[112:115], v118 offset:7040
    v_exp_f32 v12, v12
    v_exp_f32 v13, v13
    v_exp_f32 v14, v14
    v_exp_f32 v15, v15
    v_mfma_f32_32x32x16_bf16 v[56:71], v[92:95], v[124:127], 0
    ds_read_b128 v[92:95], v117 offset:1024
    v_cvt_pk_bf16_f32 v8, v8, v9
    v_cvt_pk_bf16_f32 v9, v10, v11
    v_cvt_pk_bf16_f32 v10, v12, v13
    v_cvt_pk_bf16_f32 v11, v14, v15
    v_exp_f32 v16, v16
    v_exp_f32 v17, v17
    v_exp_f32 v18, v18
    v_exp_f32 v19, v19
    v_mfma_f32_32x32x16_bf16 v[72:87], v[100:103], v[8:11], v[72:87]
    ds_read_b128 v[100:103], v118 offset:7680
    v_exp_f32 v20, v20
    v_exp_f32 v21, v21
    v_exp_f32 v22, v22
    v_exp_f32 v23, v23
    v_cvt_pk_bf16_f32 v16, v16, v17
    v_cvt_pk_bf16_f32 v17, v18, v19
    v_cvt_pk_bf16_f32 v18, v20, v21
    v_cvt_pk_bf16_f32 v19, v22, v23
    v_mfma_f32_32x32x4_2b_bf16 v[40:71], v[98:99], v[128:129], v[40:71]
    ds_read_b128 v[96:99], v117 offset:8192
    v_exp_f32 v24, v24
    v_exp_f32 v25, v25
    v_exp_f32 v26, v26
    v_exp_f32 v27, v27
    v_exp_f32 v28, v28
    v_exp_f32 v29, v29
    v_exp_f32 v30, v30
    v_exp_f32 v31, v31
    s_waitcnt lgkmcnt(4)
    v_mfma_f32_32x32x16_bf16 v[72:87], v[104:107], v[16:19], v[72:87]
    ds_read_b128 v[104:107], v118 offset:8320
    v_cvt_pk_bf16_f32 v24, v24, v25
    v_cvt_pk_bf16_f32 v25, v26, v27
    v_cvt_pk_bf16_f32 v26, v28, v29
    v_cvt_pk_bf16_f32 v27, v30, v31
    v_exp_f32 v32, v32
    v_exp_f32 v33, v33
    v_exp_f32 v34, v34
    v_exp_f32 v35, v35
    v_mfma_f32_32x32x16_bf16 v[72:87], v[108:111], v[24:27], v[72:87]
    ds_read_b128 v[108:111], v118 offset:8960
    v_exp_f32 v36, v36
    v_exp_f32 v37, v37
    v_exp_f32 v38, v38
    v_exp_f32 v39, v39
    v_cvt_pk_bf16_f32 v32, v32, v33
    v_cvt_pk_bf16_f32 v33, v34, v35
    v_cvt_pk_bf16_f32 v34, v36, v37
    v_cvt_pk_bf16_f32 v35, v38, v39
    s_waitcnt lgkmcnt(2)
    v_mfma_f32_32x32x16_bf16 v[8:23], v[88:91], v[124:127], 0
    ds_read_b128 v[88:91], v117 offset:2048
    v_exp_f32 v40, v40
    v_exp_f32 v41, v41
    v_exp_f32 v42, v42
    v_exp_f32 v43, v43
    v_mfma_f32_32x32x16_bf16 v[72:87], v[112:115], v[32:35], v[72:87]
    ds_read_b128 v[112:115], v118 offset:9600
    v_exp_f32 v44, v44
    v_exp_f32 v45, v45
    v_exp_f32 v46, v46
    v_exp_f32 v47, v47
    v_mfma_f32_32x32x16_bf16 v[24:39], v[92:95], v[124:127], 0
    ds_read_b128 v[92:95], v117 offset:3072
    v_cvt_pk_bf16_f32 v40, v40, v41
    v_cvt_pk_bf16_f32 v41, v42, v43
    v_cvt_pk_bf16_f32 v42, v44, v45
    v_cvt_pk_bf16_f32 v43, v46, v47
    v_exp_f32 v48, v48
    v_exp_f32 v49, v49
    v_exp_f32 v50, v50
    v_exp_f32 v51, v51
    v_mfma_f32_32x32x16_bf16 v[72:87], v[100:103], v[40:43], v[72:87]
    ds_read_b128 v[100:103], v119 offset:0
    v_exp_f32 v52, v52
    v_exp_f32 v53, v53
    v_exp_f32 v54, v54
    v_exp_f32 v55, v55
    v_cvt_pk_bf16_f32 v48, v48, v49
    v_cvt_pk_bf16_f32 v49, v50, v51
    v_cvt_pk_bf16_f32 v50, v52, v53
    v_cvt_pk_bf16_f32 v51, v54, v55
    v_mfma_f32_32x32x4_2b_bf16 v[8:39], v[96:97], v[128:129], v[8:39]
    v_exp_f32 v56, v56
    v_exp_f32 v57, v57
    v_exp_f32 v58, v58
    v_exp_f32 v59, v59
    v_exp_f32 v60, v60
    v_exp_f32 v61, v61
    v_exp_f32 v62, v62
    v_exp_f32 v63, v63
    s_waitcnt lgkmcnt(4)
    v_mfma_f32_32x32x16_bf16 v[72:87], v[104:107], v[48:51], v[72:87]
    ds_read_b128 v[104:107], v119 offset:640
    v_cvt_pk_bf16_f32 v56, v56, v57
    v_cvt_pk_bf16_f32 v57, v58, v59
    v_cvt_pk_bf16_f32 v58, v60, v61
    v_cvt_pk_bf16_f32 v59, v62, v63
    v_exp_f32 v64, v64
    v_exp_f32 v65, v65
    v_exp_f32 v66, v66
    v_exp_f32 v67, v67
    v_mfma_f32_32x32x16_bf16 v[72:87], v[108:111], v[56:59], v[72:87]
    ds_read_b128 v[108:111], v119 offset:1280
    v_exp_f32 v68, v68
    v_exp_f32 v69, v69
    v_exp_f32 v70, v70
    v_exp_f32 v71, v71
    v_cvt_pk_bf16_f32 v64, v64, v65
    v_cvt_pk_bf16_f32 v65, v66, v67
    v_cvt_pk_bf16_f32 v66, v68, v69
    v_cvt_pk_bf16_f32 v67, v70, v71
    s_add_u32 s90, s90, 1
    v_mov_b32 v116, v117
    v_mov_b32 v118, v119
    s_mov_b32 s80, 20480
    s_cmp_eq_u32 s90, 2
    s_cselect_b32 s80, 4294926336, s80
    s_cmp_eq_u32 s90, 5
    s_cselect_b32 s80, 4294926336, s80
    v_add_u32 v117, s80, v117
    v_add_u32 v119, s80, v119
    v_add_u32 v120, 4, v120
    s_cmp_lt_u32 s90, 8
    s_cbranch_scc1 A_LOOP
    s_waitcnt lgkmcnt(0)
    v_mfma_f32_32x32x16_bf16 v[72:87], v[112:115], v[64:67], v[72:87]
    s_nop 7
    s_nop 3
    v_mul_f32 v4, 0, v72
    v_fmac_f32 v4, 0, v73
    v_fmac_f32 v4, 0, v74
    v_fmac_f32 v4, 0, v75
    v_fmac_f32 v4, 0, v76
    v_fmac_f32 v4, 0, v77
    v_fmac_f32 v4, 0, v78
    v_fmac_f32 v4, 0, v79
    v_fmac_f32 v4, 0, v80
    v_fmac_f32 v4, 0, v81
    v_cmp_eq_f32 s[80:81], 0, v4
    v_cmp_lt_f32 vcc, 0x30800000, v82
    s_and_b64 s[80:81], s[80:81], vcc
    v_cmp_gt_f32 vcc, 0x5d800000, v82
    s_and_b64 s[80:81], s[80:81], vcc
    s_cmp_lg_u64 s[80:81], -1
    s_cbranch_scc1 A_FALLBACK
A_EPI:
    s_lshl_b32 s88, s77, 1
    s_lshr_b32 s81, s76, 2
    s_add_u32 s88, s88, s81
    s_mul_i32 s88, s88, 36864
    s_add_u32 s88, s88, 2686976
    s_and_b32 s81, s76, 3
    s_lshl_b32 s82, s78, 2
    s_add_u32 s82, s82, s81
    s_lshl_b32 s82, s82, 10
    s_add_u32 s82, s82, s88
    s_lshl_b32 s83, s78, 9
    s_lshl_b32 s81, s81, 2
    s_add_u32 s83, s83, s81
    s_add_u32 s83, s83, s88
    s_add_u32 s83, s83, 32768
    v_lshlrev_b32 v4, 4, v1
    v_rcp_f32 v5, v82
    s_nop 0
    v_mul_f32 v72, v72, v5
    v_mul_f32 v73, v73, v5
    v_mul_f32 v74, v74, v5
    v_mul_f32 v75, v75, v5
    v_mul_f32 v76, v76, v5
    v_mul_f32 v77, v77, v5
    v_mul_f32 v78, v78, v5
    v_mul_f32 v79, v79, v5
    v_mul_f32 v80, v80, v5
    v_mul_f32 v81, v81, v5
    v_cvt_pk_bf16_f32 v8, v72, v73
    v_cvt_pk_bf16_f32 v9, v74, v75
    v_cvt_pk_bf16_f32 v10, v76, v77
    v_cvt_pk_bf16_f32 v11, v78, v79
    v_cvt_pk_bf16_f32 v12, v80, v81
    buffer_store_dwordx4 v[8:11], v4, s[68:71], s82 offen sc1
    s_mov_b64 exec, 0xffffffff
    buffer_store_dword v12, v4, s[68:71], s83 offen sc1
    s_mov_b64 exec, -1
    s_mov_b32 s56, s44
    s_and_b32 s57, s45, 0xffff
    s_mov_b32 s58, 4718592
    s_mov_b32 s59, 0x00020000
    s_and_b32 s80, s76, 3
    s_mul_i32 s92, s80, 36
    s_and_b32 s80, s80, 1
    s_lshl_b32 s80, s80, 2
    s_add_u32 s92, s92, s80
    s_mov_b32 s93, 1145319952
    v_lshrrev_b32 v6, 5, v1
    v_lshlrev_b32 v165, 4, v1
    v_lshlrev_b32 v4, 1, v6
    v_bfe_u32 v5, v1, 2, 2
    v_lshl_add_u32 v4, v5, 2, v4
    v_mul_u32_u24 v4, 144, v4
    v_bfe_u32 v5, v1, 4, 1
    v_and_b32 v6, 3, v1
    v_lshl_add_u32 v5, v5, 2, v6
    v_lshlrev_b32 v5, 2, v5
    v_lshrrev_b32 v5, v5, s93
    v_and_b32 v5, 7, v5
    v_lshl_add_u32 v4, v5, 3, v4
    s_add_u32 s80, s92, 80896
    v_add_u32 v164, s80, v4
    s_and_b32 s87, s76, 4
    v_mov_b32 v166, s87
    s_lshl_b32 s81, s77, 10
    s_lshl_b32 s82, s87, 3
    s_add_u32 s81, s81, s82
    s_lshl_b32 s82, s78, 2
    s_add_u32 s81, s81, s82
    s_add_u32 s81, s81, 8331264
    v_lshlrev_b32 v5, 7, v1
    s_waitcnt vmcnt(0)
    s_mov_b64 exec, 1
    ds_add_rtn_u32 v4, v166, v3 offset:128
    s_waitcnt lgkmcnt(0)
    v_readfirstlane_b32 s80, v4
    s_cmp_lg_u32 s80, 3
    s_cbranch_scc1 A_NPUB
    s_mov_b64 exec, 0xff
    buffer_store_dword v3, v5, s[68:71], s81 offen sc1
A_NPUB:
    s_mov_b64 exec, -1
    s_mov_b32 s99, 0x80000
W_19:
    ds_read_b32 v4, v2 offset:140
    s_waitcnt lgkmcnt(0)
    v_readfirstlane_b32 s80, v4
    s_cmp_ge_u32 s80, 2
    s_cbranch_scc1 WD_20
    s_sleep 1
    s_sub_u32 s99, s99, 1
    s_cmp_lg_u32 s99, 0
    s_cbranch_scc1 W_19
WD_20:
    ds_read_b64_tr_b16 v[36:37], v164 offset:0
    ds_read_b64_tr_b16 v[38:39], v164 offset:144
    ds_read_b64_tr_b16 v[40:41], v164 offset:2304
    ds_read_b64_tr_b16 v[42:43], v164 offset:2448
    ds_read_b64_tr_b16 v[44:45], v164 offset:4608
    ds_read_b64_tr_b16 v[46:47], v164 offset:4752
    ds_read_b64_tr_b16 v[48:49], v164 offset:6912
    ds_read_b64_tr_b16 v[50:51], v164 offset:7056
    ds_read_b64_tr_b16 v[52:53], v164 offset:9216
    ds_read_b64_tr_b16 v[54:55], v164 offset:9360
    ds_read_b64_tr_b16 v[56:57], v164 offset:11520
    ds_read_b64_tr_b16 v[58:59], v164 offset:11664
    ds_read_b64_tr_b16 v[60:61], v164 offset:13824
    ds_read_b64_tr_b16 v[62:63], v164 offset:13968
    ds_read_b64_tr_b16 v[64:65], v164 offset:16128
    ds_read_b64_tr_b16 v[66:67], v164 offset:16272
    ds_read_b64_tr_b16 v[68:69], v164 offset:18432
    ds_read_b64_tr_b16 v[70:71], v164 offset:18576
    ds_read_b64_tr_b16 v[72:73], v164 offset:20736
    ds_read_b64_tr_b16 v[74:75], v164 offset:20880
    ds_read_b64_tr_b16 v[76:77], v164 offset:23040
    ds_read_b64_tr_b16 v[78:79], v164 offset:23184
    ds_read_b64_tr_b16 v[80:81], v164 offset:25344
    ds_read_b64_tr_b16 v[82:83], v164 offset:25488
    ds_read_b64_tr_b16 v[84:85], v164 offset:27648
    ds_read_b64_tr_b16 v[86:87], v164 offset:27792
    ds_read_b64_tr_b16 v[88:89], v164 offset:29952
    ds_read_b64_tr_b16 v[90:91], v164 offset:30096
    ds_read_b64_tr_b16 v[92:93], v164 offset:32256
    ds_read_b64_tr_b16 v[94:95], v164 offset:32400
    ds_read_b64_tr_b16 v[96:97], v164 offset:34560
    ds_read_b64_tr_b16 v[98:99], v164 offset:34704
    v_add_u32 v164, 36864, v164
    ds_read_b64_tr_b16 v[100:101], v164 offset:0
    ds_read_b64_tr_b16 v[102:103], v164 offset:144
    ds_read_b64_tr_b16 v[104:105], v164 offset:2304
    ds_read_b64_tr_b16 v[106:107], v164 offset:2448
    ds_read_b64_tr_b16 v[108:109], v164 offset:4608
    ds_read_b64_tr_b16 v[110:111], v164 offset:4752
    ds_read_b64_tr_b16 v[112:113], v164 offset:6912
    ds_read_b64_tr_b16 v[114:115], v164 offset:7056
    ds_read_b64_tr_b16 v[116:117], v164 offset:9216
    ds_read_b64_tr_b16 v[118:119], v164 offset:9360
    ds_read_b64_tr_b16 v[120:121], v164 offset:11520
    ds_read_b64_tr_b16 v[122:123], v164 offset:11664
    ds_read_b64_tr_b16 v[124:125], v164 offset:13824
    ds_read_b64_tr_b16 v[126:127], v164 offset:13968
    ds_read_b64_tr_b16 v[128:129], v164 offset:16128
    ds_read_b64_tr_b16 v[130:131], v164 offset:16272
    ds_read_b64_tr_b16 v[132:133], v164 offset:18432
    ds_read_b64_tr_b16 v[134:135], v164 offset:18576
    ds_read_b64_tr_b16 v[136:137], v164 offset:20736
    ds_read_b64_tr_b16 v[138:139], v164 offset:20880
    ds_read_b64_tr_b16 v[140:141], v164 offset:23040
    ds_read_b64_tr_b16 v[142:143], v164 offset:23184
    ds_read_b64_tr_b16 v[144:145], v164 offset:25344
    ds_read_b64_tr_b16 v[146:147], v164 offset:25488
    ds_read_b64_tr_b16 v[148:149], v164 offset:27648
    ds_read_b64_tr_b16 v[150:151], v164 offset:27792
    ds_read_b64_tr_b16 v[152:153], v164 offset:29952
    ds_read_b64_tr_b16 v[154:155], v164 offset:30096
    ds_read_b64_tr_b16 v[156:157], v164 offset:32256
    ds_read_b64_tr_b16 v[158:159], v164 offset:32400
    ds_read_b64_tr_b16 v[160:161], v164 offset:34560
    ds_read_b64_tr_b16 v[162:163], v164 offset:34704
    s_cmp_eq_u32 s87, 0
    s_mov_b32 s84, 256
    s_cselect_b32 s84, 61696, s84
    s_mov_b32 s85, 20736
    s_cselect_b32 s85, 41216, s85
    s_and_b32 s86, s76, 3
    s_lshl_b32 s86, s86, 10
    s_add_u32 s88, s88, s86
    s_mov_b32 s99, 0x80000
W_21:
    ds_read_b32 v4, v166 offset:144
    s_waitcnt lgkmcnt(0)
    v_readfirstlane_b32 s80, v4
    s_cmp_ge_u32 s80, 1
    s_cbranch_scc1 WD_22
    s_sleep 1
    s_sub_u32 s99, s99, 1
    s_cmp_lg_u32 s99, 0
    s_cbranch_scc1 W_21
WD_22:
    s_add_u32 s80, s84, 0
    s_add_u32 m0, s80, s86
    s_add_u32 s81, s88, 0
    buffer_load_dwordx4 v165, s[68:71], s81 offen sc1 lds
    s_add_u32 s80, s84, 4096
    s_add_u32 m0, s80, s86
    s_add_u32 s81, s88, 4096
    buffer_load_dwordx4 v165, s[68:71], s81 offen sc1 lds
    s_add_u32 s80, s84, 8192
    s_add_u32 m0, s80, s86
    s_add_u32 s81, s88, 8192
    buffer_load_dwordx4 v165, s[68:71], s81 offen sc1 lds
    s_add_u32 s80, s84, 12288
    s_add_u32 m0, s80, s86
    s_add_u32 s81, s88, 12288
    buffer_load_dwordx4 v165, s[68:71], s81 offen sc1 lds
    s_add_u32 s80, s84, 16384
    s_sub_u32 s81, s85, 2048
    s_cmp_lt_u32 s86, 2048
    s_cselect_b32 s80, s80, s81
    s_add_u32 m0, s80, s86
    s_add_u32 s81, s88, 16384
    buffer_load_dwordx4 v165, s[68:71], s81 offen sc1 lds
    s_add_u32 s80, s85, 2048
    s_add_u32 m0, s80, s86
    s_add_u32 s81, s88, 20480
    buffer_load_dwordx4 v165, s[68:71], s81 offen sc1 lds
    s_add_u32 s80, s85, 6144
    s_add_u32 m0, s80, s86
    s_add_u32 s81, s88, 24576
    buffer_load_dwordx4 v165, s[68:71], s81 offen sc1 lds
    s_add_u32 s80, s85, 10240
    s_add_u32 m0, s80, s86
    s_add_u32 s81, s88, 28672
    buffer_load_dwordx4 v165, s[68:71], s81 offen sc1 lds
    s_add_u32 s80, s85, 14336
    s_add_u32 m0, s80, s86
    s_add_u32 s81, s88, 32768
    buffer_load_dwordx4 v165, s[68:71], s81 offen sc1 lds
    v_add_u32 v6, s84, v165
    v_add_u32 v7, s85, v165
    v_lshlrev_b32 v166, 2, v166
    s_waitcnt vmcnt(6)
    s_mov_b64 exec, 1
    ds_add_u32 v166, v3 offset:160
    s_mov_b64 exec, -1
    s_mov_b32 s99, 0x80000
W_23:
    ds_read_b32 v4, v166 offset:160
    s_waitcnt lgkmcnt(0)
    v_readfirstlane_b32 s80, v4
    s_cmp_ge_u32 s80, 4
    s_cbranch_scc1 WD_24
    s_sleep 1
    s_sub_u32 s99, s99, 1
    s_cmp_lg_u32 s99, 0
    s_cbranch_scc1 W_23
WD_24:
    ds_read_b128 v[8:11], v6 offset:0
    ds_read_b128 v[12:15], v6 offset:1024
    ds_read_b128 v[32:35], v6 offset:2048
    s_waitcnt lgkmcnt(2)
    v_mfma_f32_32x32x16_bf16 v[16:31], v[36:39], v[8:11], 0
    ds_read_b128 v[36:39], v6 offset:3072
    s_waitcnt lgkmcnt(2)
    v_mfma_f32_32x32x16_bf16 v[16:31], v[40:43], v[12:15], v[16:31]
    ds_read_b128 v[40:43], v6 offset:4096
    s_waitcnt lgkmcnt(2)
    v_mfma_f32_32x32x16_bf16 v[16:31], v[44:47], v[32:35], v[16:31]
    ds_read_b128 v[44:47], v6 offset:5120
    s_waitcnt lgkmcnt(2)
    v_mfma_f32_32x32x16_bf16 v[16:31], v[48:51], v[36:39], v[16:31]
    ds_read_b128 v[48:51], v6 offset:6144
    s_waitcnt lgkmcnt(2)
    v_mfma_f32_32x32x16_bf16 v[16:31], v[52:55], v[40:43], v[16:31]
    ds_read_b128 v[52:55], v6 offset:7168
    s_waitcnt lgkmcnt(2)
    v_mfma_f32_32x32x16_bf16 v[16:31], v[56:59], v[44:47], v[16:31]
    ds_read_b128 v[56:59], v6 offset:8192
    s_waitcnt lgkmcnt(2)
    v_mfma_f32_32x32x16_bf16 v[16:31], v[60:63], v[48:51], v[16:31]
    ds_read_b128 v[60:63], v6 offset:9216
    s_waitcnt lgkmcnt(2)
    v_mfma_f32_32x32x16_bf16 v[16:31], v[64:67], v[52:55], v[16:31]
    ds_read_b128 v[64:67], v6 offset:10240
    s_waitcnt lgkmcnt(2)
    v_mfma_f32_32x32x16_bf16 v[16:31], v[68:71], v[56:59], v[16:31]
    ds_read_b128 v[68:71], v6 offset:11264
    s_waitcnt lgkmcnt(2)
    v_mfma_f32_32x32x16_bf16 v[16:31], v[72:75], v[60:63], v[16:31]
    s_waitcnt lgkmcnt(1)
    v_mfma_f32_32x32x16_bf16 v[16:31], v[76:79], v[64:67], v[16:31]
    s_waitcnt lgkmcnt(0)
    v_mfma_f32_32x32x16_bf16 v[16:31], v[80:83], v[68:71], v[16:31]
    s_waitcnt vmcnt(3)
    s_mov_b64 exec, 1
    ds_add_u32 v166, v3 offset:164
    s_mov_b64 exec, -1
    s_mov_b32 s99, 0x80000
W_25:
    ds_read_b32 v4, v166 offset:164
    s_waitcnt lgkmcnt(0)
    v_readfirstlane_b32 s80, v4
    s_cmp_ge_u32 s80, 4
    s_cbranch_scc1 WD_26
    s_sleep 1
    s_sub_u32 s99, s99, 1
    s_cmp_lg_u32 s99, 0
    s_cbranch_scc1 W_25
WD_26:
    ds_read_b128 v[72:75], v6 offset:12288
    ds_read_b128 v[76:79], v6 offset:13312
    ds_read_b128 v[80:83], v6 offset:14336
    s_waitcnt lgkmcnt(2)
    v_mfma_f32_32x32x16_bf16 v[16:31], v[84:87], v[72:75], v[16:31]
    ds_read_b128 v[84:87], v6 offset:15360
    s_waitcnt lgkmcnt(2)
    v_mfma_f32_32x32x16_bf16 v[16:31], v[88:91], v[76:79], v[16:31]
    ds_read_b128 v[88:91], v6 offset:16384
    s_waitcnt lgkmcnt(2)
    v_mfma_f32_32x32x16_bf16 v[16:31], v[92:95], v[80:83], v[16:31]
    ds_read_b128 v[92:95], v6 offset:17408
    s_waitcnt lgkmcnt(2)
    v_mfma_f32_32x32x16_bf16 v[16:31], v[96:99], v[84:87], v[16:31]
    ds_read_b128 v[96:99], v7 offset:0
    s_waitcnt lgkmcnt(2)
    v_mfma_f32_32x32x16_bf16 v[16:31], v[100:103], v[88:91], v[16:31]
    ds_read_b128 v[100:103], v7 offset:1024
    s_waitcnt lgkmcnt(2)
    v_mfma_f32_32x32x16_bf16 v[16:31], v[104:107], v[92:95], v[16:31]
    ds_read_b128 v[104:107], v7 offset:2048
    s_waitcnt lgkmcnt(2)
    v_mfma_f32_32x32x16_bf16 v[16:31], v[108:111], v[96:99], v[16:31]
    ds_read_b128 v[108:111], v7 offset:3072
    s_waitcnt lgkmcnt(2)
    v_mfma_f32_32x32x16_bf16 v[16:31], v[112:115], v[100:103], v[16:31]
    ds_read_b128 v[112:115], v7 offset:4096
    s_waitcnt lgkmcnt(2)
    v_mfma_f32_32x32x16_bf16 v[16:31], v[116:119], v[104:107], v[16:31]
    ds_read_b128 v[116:119], v7 offset:5120
    s_waitcnt lgkmcnt(2)
    v_mfma_f32_32x32x16_bf16 v[16:31], v[120:123], v[108:111], v[16:31]
    s_waitcnt lgkmcnt(1)
    v_mfma_f32_32x32x16_bf16 v[16:31], v[124:127], v[112:115], v[16:31]
    s_waitcnt lgkmcnt(0)
    v_mfma_f32_32x32x16_bf16 v[16:31], v[128:131], v[116:119], v[16:31]
    s_waitcnt vmcnt(0)
    s_mov_b64 exec, 1
    ds_add_u32 v166, v3 offset:168
    s_mov_b64 exec, -1
    s_mov_b32 s99, 0x80000
W_27:
    ds_read_b32 v4, v166 offset:168
    s_waitcnt lgkmcnt(0)
    v_readfirstlane_b32 s80, v4
    s_cmp_ge_u32 s80, 4
    s_cbranch_scc1 WD_28
    s_sleep 1
    s_sub_u32 s99, s99, 1
    s_cmp_lg_u32 s99, 0
    s_cbranch_scc1 W_27
WD_28:
    ds_read_b64_tr_b16 v[36:37], v164 offset:36864
    ds_read_b64_tr_b16 v[38:39], v164 offset:37008
    ds_read_b64_tr_b16 v[40:41], v164 offset:39168
    ds_read_b64_tr_b16 v[42:43], v164 offset:39312
    ds_read_b64_tr_b16 v[44:45], v164 offset:41472
    ds_read_b64_tr_b16 v[46:47], v164 offset:41616
    ds_read_b64_tr_b16 v[48:49], v164 offset:43776
    ds_read_b64_tr_b16 v[50:51], v164 offset:43920
    ds_read_b128 v[120:123], v7 offset:6144
    ds_read_b128 v[124:127], v7 offset:7168
    ds_read_b128 v[128:131], v7 offset:8192
    s_waitcnt lgkmcnt(2)
    v_mfma_f32_32x32x16_bf16 v[16:31], v[132:135], v[120:123], v[16:31]
    ds_read_b128 v[132:135], v7 offset:9216
    s_waitcnt lgkmcnt(2)
    v_mfma_f32_32x32x16_bf16 v[16:31], v[136:139], v[124:127], v[16:31]
    ds_read_b128 v[136:139], v7 offset:10240
    s_waitcnt lgkmcnt(2)
    v_mfma_f32_32x32x16_bf16 v[16:31], v[140:143], v[128:131], v[16:31]
    ds_read_b128 v[140:143], v7 offset:11264
    s_waitcnt lgkmcnt(2)
    v_mfma_f32_32x32x16_bf16 v[16:31], v[144:147], v[132:135], v[16:31]
    ds_read_b128 v[144:147], v7 offset:12288
    s_waitcnt lgkmcnt(2)
    v_mfma_f32_32x32x16_bf16 v[16:31], v[148:151], v[136:139], v[16:31]
    ds_read_b128 v[148:151], v7 offset:13312
    s_waitcnt lgkmcnt(2)
    v_mfma_f32_32x32x16_bf16 v[16:31], v[152:155], v[140:143], v[16:31]
    ds_read_b128 v[152:155], v7 offset:14336
    s_waitcnt lgkmcnt(2)
    v_mfma_f32_32x32x16_bf16 v[16:31], v[156:159], v[144:147], v[16:31]
    ds_read_b128 v[156:159], v7 offset:15360
    s_waitcnt lgkmcnt(2)
    v_mfma_f32_32x32x16_bf16 v[16:31], v[160:163], v[148:151], v[16:31]
    ds_read_b128 v[160:163], v7 offset:16384
    s_waitcnt lgkmcnt(2)
    v_mfma_f32_32x32x16_bf16 v[16:31], v[36:39], v[152:155], v[16:31]
    ds_read_b128 v[36:39], v7 offset:17408
    s_waitcnt lgkmcnt(2)
    v_mfma_f32_32x32x16_bf16 v[16:31], v[40:43], v[156:159], v[16:31]
    s_waitcnt lgkmcnt(1)
    v_mfma_f32_32x32x16_bf16 v[16:31], v[44:47], v[160:163], v[16:31]
    s_waitcnt lgkmcnt(0)
    v_mfma_f32_32x32x16_bf16 v[16:31], v[48:51], v[36:39], v[16:31]
    s_lshl_b32 s80, s77, 1
    s_lshr_b32 s81, s76, 2
    s_add_u32 s80, s80, s81
    s_mul_i32 s80, s80, 73728
    s_mul_i32 s81, s78, 144
    s_add_u32 s80, s80, s81
    s_add_u32 s80, s80, s92
    s_add_u32 s80, s80, 1152
    v_and_b32 v4, 31, v1
    v_mul_u32_u24 v4, 2304, v4
    v_lshrrev_b32 v5, 5, v1
    v_lshl_add_u32 v4, v5, 4, v4
    s_nop 3
    v_cvt_pk_bf16_f32 v36, v16, v17
    v_cvt_pk_bf16_f32 v37, v18, v19
    v_cvt_pk_bf16_f32 v38, v20, v21
    v_cvt_pk_bf16_f32 v39, v22, v23
    v_cvt_pk_bf16_f32 v40, v24, v25
    v_cvt_pk_bf16_f32 v41, v26, v27
    v_permlane32_swap_b32 v36, v38
    v_permlane32_swap_b32 v37, v39
    buffer_store_dwordx4 v[36:39], v4, s[56:59], s80 offen
    s_bitcmp1_b32 s76, 0
    s_cbranch_scc1 A_NO5
    s_mov_b64 exec, 0xffffffff
    buffer_store_dwordx2 v[40:41], v4, s[56:59], s80 offen offset:32
    s_mov_b64 exec, -1
A_NO5:
    s_endpgm
A_FALLBACK:
    v_mov_b32 v129, 0
    v_mov_b32 v121, 0xff800000
    v_lshlrev_b32 v120, 4, v1
    s_mov_b32 s84, 0
    v_mov_b32 v72, 0
    v_mov_b32 v73, 0
    v_mov_b32 v74, 0
    v_mov_b32 v75, 0
    v_mov_b32 v76, 0
    v_mov_b32 v77, 0
    v_mov_b32 v78, 0
    v_mov_b32 v79, 0
    v_mov_b32 v80, 0
    v_mov_b32 v81, 0
    v_mov_b32 v82, 0
    v_mov_b32 v83, 0
    v_mov_b32 v84, 0
    v_mov_b32 v85, 0
    v_mov_b32 v86, 0
    v_mov_b32 v87, 0
F_PASS:
    s_mov_b32 s85, 0
F_LOOP:
    s_lshr_b32 s80, s85, 2
    s_mul_i32 s80, s80, 20480
    s_add_u32 s80, s80, 2490368
    s_and_b32 s81, s85, 3
    s_lshl_b32 s82, s81, 11
    s_add_u32 s82, s82, s80
    buffer_load_dwordx4 v[88:91], v120, s[68:71], s82 offen sc1
    buffer_load_dwordx4 v[92:95], v120, s[68:71], s82 offen offset:1024 sc1
    s_lshr_b32 s82, s81, 1
    s_lshl_b32 s82, s82, 10
    s_and_b32 s83, s81, 1
    s_lshl_b32 s83, s83, 3
    s_add_u32 s82, s82, s83
    s_add_u32 s82, s82, s80
    s_add_u32 s82, s82, 8192
    buffer_load_dwordx2 v[96:97], v120, s[68:71], s82 offen sc1
    s_mul_i32 s82, s81, 2560
    s_add_u32 s82, s82, s80
    s_add_u32 s82, s82, 10240
    buffer_load_dwordx4 v[100:103], v122, s[68:71], s82 offen offset:0 sc1
    buffer_load_dwordx4 v[104:107], v122, s[68:71], s82 offen offset:640 sc1
    buffer_load_dwordx4 v[108:111], v122, s[68:71], s82 offen offset:1280 sc1
    buffer_load_dwordx4 v[112:115], v122, s[68:71], s82 offen offset:1920 sc1
    s_waitcnt vmcnt(0)
    v_mfma_f32_32x32x16_bf16 v[8:23], v[88:91], v[124:127], 0
    v_mfma_f32_32x32x16_bf16 v[24:39], v[92:95], v[124:127], 0
    s_nop 9
    v_mfma_f32_32x32x4_2b_bf16 v[8:39], v[96:97], v[128:129], v[8:39]
    s_nop 15
    s_nop 4
    s_cmp_lg_u32 s84, 0
    s_cbranch_scc1 F_ACC
    v_max3_f32 v121, v121, v8, v9
    v_max3_f32 v121, v121, v10, v11
    v_max3_f32 v121, v121, v12, v13
    v_max3_f32 v121, v121, v14, v15
    v_max3_f32 v121, v121, v16, v17
    v_max3_f32 v121, v121, v18, v19
    v_max3_f32 v121, v121, v20, v21
    v_max3_f32 v121, v121, v22, v23
    v_max3_f32 v121, v121, v24, v25
    v_max3_f32 v121, v121, v26, v27
    v_max3_f32 v121, v121, v28, v29
    v_max3_f32 v121, v121, v30, v31
    v_max3_f32 v121, v121, v32, v33
    v_max3_f32 v121, v121, v34, v35
    v_max3_f32 v121, v121, v36, v37
    v_max3_f32 v121, v121, v38, v39
    s_branch F_NEXT
F_ACC:
    v_sub_f32 v8, v8, v121
    v_sub_f32 v9, v9, v121
    v_sub_f32 v10, v10, v121
    v_sub_f32 v11, v11, v121
    v_sub_f32 v12, v12, v121
    v_sub_f32 v13, v13, v121
    v_sub_f32 v14, v14, v121
    v_sub_f32 v15, v15, v121
    v_sub_f32 v16, v16, v121
    v_sub_f32 v17, v17, v121
    v_sub_f32 v18, v18, v121
    v_sub_f32 v19, v19, v121
    v_sub_f32 v20, v20, v121
    v_sub_f32 v21, v21, v121
    v_sub_f32 v22, v22, v121
    v_sub_f32 v23, v23, v121
    v_sub_f32 v24, v24, v121
    v_sub_f32 v25, v25, v121
    v_sub_f32 v26, v26, v121
    v_sub_f32 v27, v27, v121
    v_sub_f32 v28, v28, v121
    v_sub_f32 v29, v29, v121
    v_sub_f32 v30, v30, v121
    v_sub_f32 v31, v31, v121
    v_sub_f32 v32, v32, v121
    v_sub_f32 v33, v33, v121
    v_sub_f32 v34, v34, v121
    v_sub_f32 v35, v35, v121
    v_sub_f32 v36, v36, v121
    v_sub_f32 v37, v37, v121
    v_sub_f32 v38, v38, v121
    v_sub_f32 v39, v39, v121
    v_exp_f32 v8, v8
    v_exp_f32 v9, v9
    v_exp_f32 v10, v10
    v_exp_f32 v11, v11
    v_exp_f32 v12, v12
    v_exp_f32 v13, v13
    v_exp_f32 v14, v14
    v_exp_f32 v15, v15
    v_exp_f32 v16, v16
    v_exp_f32 v17, v17
    v_exp_f32 v18, v18
    v_exp_f32 v19, v19
    v_exp_f32 v20, v20
    v_exp_f32 v21, v21
    v_exp_f32 v22, v22
    v_exp_f32 v23, v23
    v_exp_f32 v24, v24
    v_exp_f32 v25, v25
    v_exp_f32 v26, v26
    v_exp_f32 v27, v27
    v_exp_f32 v28, v28
    v_exp_f32 v29, v29
    v_exp_f32 v30, v30
    v_exp_f32 v31, v31
    v_exp_f32 v32, v32
    v_exp_f32 v33, v33
    v_exp_f32 v34, v34
    v_exp_f32 v35, v35
    v_exp_f32 v36, v36
    v_exp_f32 v37, v37
    v_exp_f32 v38, v38
    v_exp_f32 v39, v39
    v_cvt_pk_bf16_f32 v40, v8, v9
    v_cvt_pk_bf16_f32 v41, v10, v11
    v_cvt_pk_bf16_f32 v42, v12, v13
    v_cvt_pk_bf16_f32 v43, v14, v15
    v_cvt_pk_bf16_f32 v44, v16, v17
    v_cvt_pk_bf16_f32 v45, v18, v19
    v_cvt_pk_bf16_f32 v46, v20, v21
    v_cvt_pk_bf16_f32 v47, v22, v23
    v_cvt_pk_bf16_f32 v48, v24, v25
    v_cvt_pk_bf16_f32 v49, v26, v27
    v_cvt_pk_bf16_f32 v50, v28, v29
    v_cvt_pk_bf16_f32 v51, v30, v31
    v_cvt_pk_bf16_f32 v52, v32, v33
    v_cvt_pk_bf16_f32 v53, v34, v35
    v_cvt_pk_bf16_f32 v54, v36, v37
    v_cvt_pk_bf16_f32 v55, v38, v39
    s_nop 1
    v_mfma_f32_32x32x16_bf16 v[72:87], v[100:103], v[40:43], v[72:87]
    v_mfma_f32_32x32x16_bf16 v[72:87], v[104:107], v[44:47], v[72:87]
    v_mfma_f32_32x32x16_bf16 v[72:87], v[108:111], v[48:51], v[72:87]
    v_mfma_f32_32x32x16_bf16 v[72:87], v[112:115], v[52:55], v[72:87]
F_NEXT:
    s_add_u32 s85, s85, 1
    s_cmp_lt_u32 s85, 32
    s_cbranch_scc1 F_LOOP
    s_cmp_lg_u32 s84, 0
    s_cbranch_scc1 F_DONE
    v_mov_b32 v4, v121
    s_nop 1
    v_permlane32_swap_b32 v121, v4
    s_nop 1
    v_max_f32 v121, v121, v4
    s_mov_b32 s84, 1
    s_branch F_PASS
F_DONE:
    s_nop 7
    s_nop 3
    s_branch A_EPI
M_HELP:
    s_getpc_b64 s[6:7]
M_PC:
    s_sub_u32 s6, s6, M_PC-concat_heads__ssm_conv_s4__grouped_kv_mqa__prompt_kernel
    s_subb_u32 s7, s7, 0
    s_sub_u32 s80, s76, 8
    s_lshl_b32 s80, s80, 13
    v_lshlrev_b32 v4, 7, v1
    v_add_u32 v4, s80, v4
    v_min_u32 v4, MAIN_END-concat_heads__ssm_conv_s4__grouped_kv_mqa__prompt_kernel, v4
    global_load_dword v166, v4, s[6:7]
    s_mov_b32 s94, 0x05040100
    s_mov_b32 s95, 0x07060302
    s_cmp_lt_u32 s76, 11
    s_cbranch_scc1 M_SSM
    s_nop 0
    v_lshlrev_b32 v4, 2, v1
    v_cmp_eq_u32 vcc, 16, v1
    s_nop 1
    v_cndmask_b32 v5, 0, v3, vcc
    v_lshlrev_b32 v5, 3, v5
    ds_write_b32 v4, v5
    s_waitcnt lgkmcnt(0)
    s_barrier
    s_mov_b32 s68, s48
    s_and_b32 s69, s49, 0xffff
    s_mov_b32 s70, 8388608
    s_mov_b32 s71, 0x00020000
    s_mov_b32 s72, s46
    s_and_b32 s73, s47, 0xffff
    s_mov_b32 s74, 256
    s_mov_b32 s75, 0x00020000
    s_cmp_ge_u32 s78, 2
    s_cbranch_scc1 M_LOADER
    s_branch M_LOADP
M_LOADER:
    v_lshlrev_b32 v9, 4, v1
    s_setprio 3
    s_cmp_lt_u32 s78, 2
    s_cselect_b32 s87, 0, 3
    s_mov_b32 s56, s36
    s_and_b32 s57, s37, 0xffff
    s_mov_b32 s58, 663552
    s_mov_b32 s59, 0x00020000
    s_sub_u32 s79, s76, 8
    s_min_u32 s79, s79, 2
    s_add_u32 s83, s79, 0
    s_lshl_b32 s80, s83, 6
    v_add_u32 v4, s80, v1
    v_mul_u32_u24 v5, 7282, v4
    v_lshrrev_b32 v5, 16, v5
    v_mul_u32_u24 v6, 9, v5
    v_sub_u32 v6, v4, v6
    v_and_b32 v4, 3, v5
    v_bfe_u32 v7, v5, 2, 2
    v_lshl_add_u32 v4, v4, 2, v7
    v_and_b32 v5, 0x30, v5
    v_add_u32 v5, v5, v4
    v_mul_u32_u24 v4, 1152, v5
    v_lshl_add_u32 v12, v6, 4, v4
    s_add_u32 s83, s79, 3
    s_lshl_b32 s80, s83, 6
    v_add_u32 v4, s80, v1
    v_mul_u32_u24 v5, 7282, v4
    v_lshrrev_b32 v5, 16, v5
    v_mul_u32_u24 v6, 9, v5
    v_sub_u32 v6, v4, v6
    v_and_b32 v4, 3, v5
    v_bfe_u32 v7, v5, 2, 2
    v_lshl_add_u32 v4, v4, 2, v7
    v_and_b32 v5, 0x30, v5
    v_add_u32 v5, v5, v4
    v_mul_u32_u24 v4, 1152, v5
    v_lshl_add_u32 v13, v6, 4, v4
    s_add_u32 s83, s79, 6
    s_lshl_b32 s80, s83, 6
    v_add_u32 v4, s80, v1
    v_mul_u32_u24 v5, 7282, v4
    v_lshrrev_b32 v5, 16, v5
    v_mul_u32_u24 v6, 9, v5
    v_sub_u32 v6, v4, v6
    v_and_b32 v4, 3, v5
    v_bfe_u32 v7, v5, 2, 2
    v_lshl_add_u32 v4, v4, 2, v7
    v_and_b32 v5, 0x30, v5
    v_add_u32 v5, v5, v4
    v_mul_u32_u24 v4, 1152, v5
    v_lshl_add_u32 v14, v6, 4, v4
    s_mul_i32 s8, s78, 144
    s_lshl_b32 s9, s79, 10
    s_add_u32 s9, s9, 256
SW_29:
    s_add_u32 m0, s9, 0
    s_nop 0
    buffer_load_dwordx4 v12, s[56:59], s8 offen lds
    s_add_u32 m0, s9, 3072
    s_nop 0
    buffer_load_dwordx4 v13, s[56:59], s8 offen lds
    s_add_u32 m0, s9, 6144
    s_nop 0
    buffer_load_dwordx4 v14, s[56:59], s8 offen lds
    s_add_u32 s9, s9, 9216
    s_add_u32 s8, s8, 73728
    s_cmp_lt_u32 s9, 55552
    s_cbranch_scc1 SW_29
    s_waitcnt vmcnt(9)
    s_mov_b64 exec, 1
    ds_add_u32 v2, v3 offset:112
    s_mov_b64 exec, -1
SW_30:
    s_add_u32 m0, s9, 0
    s_nop 0
    buffer_load_dwordx4 v12, s[56:59], s8 offen lds
    s_add_u32 m0, s9, 3072
    s_nop 0
    buffer_load_dwordx4 v13, s[56:59], s8 offen lds
    s_add_u32 m0, s9, 6144
    s_nop 0
    buffer_load_dwordx4 v14, s[56:59], s8 offen lds
    s_add_u32 s9, s9, 9216
    s_add_u32 s8, s8, 73728
    s_cmp_lt_u32 s9, 83200
    s_cbranch_scc1 SW_30
    s_waitcnt vmcnt(9)
    s_mov_b64 exec, 1
    ds_add_u32 v2, v3 offset:116
    s_mov_b64 exec, -1
    s_waitcnt vmcnt(0)
    s_mov_b64 exec, 1
    ds_add_u32 v2, v3 offset:120
    s_mov_b64 exec, -1
    s_branch M_LD2
M_LOADP:
    v_lshlrev_b32 v9, 4, v1
    s_setprio 3
    s_mov_b32 s87, 0
    s_mov_b32 s56, s36
    s_and_b32 s57, s37, 0xffff
    s_mov_b32 s58, 663552
    s_mov_b32 s59, 0x00020000
    s_sub_u32 s79, s76, 8
    s_min_u32 s79, s79, 2
    s_add_u32 s83, s79, 0
    s_lshl_b32 s80, s83, 6
    v_add_u32 v4, s80, v1
    v_mul_u32_u24 v5, 7282, v4
    v_lshrrev_b32 v5, 16, v5
    v_mul_u32_u24 v6, 9, v5
    v_sub_u32 v6, v4, v6
    v_and_b32 v4, 3, v5
    v_bfe_u32 v7, v5, 2, 2
    v_lshl_add_u32 v4, v4, 2, v7
    v_and_b32 v5, 0x30, v5
    v_add_u32 v5, v5, v4
    v_mul_u32_u24 v4, 1152, v5
    v_lshl_add_u32 v12, v6, 4, v4
    s_add_u32 s83, s79, 3
    s_lshl_b32 s80, s83, 6
    v_add_u32 v4, s80, v1
    v_mul_u32_u24 v5, 7282, v4
    v_lshrrev_b32 v5, 16, v5
    v_mul_u32_u24 v6, 9, v5
    v_sub_u32 v6, v4, v6
    v_and_b32 v4, 3, v5
    v_bfe_u32 v7, v5, 2, 2
    v_lshl_add_u32 v4, v4, 2, v7
    v_and_b32 v5, 0x30, v5
    v_add_u32 v5, v5, v4
    v_mul_u32_u24 v4, 1152, v5
    v_lshl_add_u32 v13, v6, 4, v4
    s_add_u32 s83, s79, 6
    s_lshl_b32 s80, s83, 6
    v_add_u32 v4, s80, v1
    v_mul_u32_u24 v5, 7282, v4
    v_lshrrev_b32 v5, 16, v5
    v_mul_u32_u24 v6, 9, v5
    v_sub_u32 v6, v4, v6
    v_and_b32 v4, 3, v5
    v_bfe_u32 v7, v5, 2, 2
    v_lshl_add_u32 v4, v4, 2, v7
    v_and_b32 v5, 0x30, v5
    v_add_u32 v5, v5, v4
    v_mul_u32_u24 v4, 1152, v5
    v_lshl_add_u32 v14, v6, 4, v4
    s_mul_i32 s8, s78, 144
    s_lshl_b32 s9, s79, 10
    s_add_u32 s9, s9, 256
    s_mov_b32 s99, 0x80000
W_31:
    ds_read_b32 v4, v2 offset:0
    s_waitcnt lgkmcnt(0)
    v_readfirstlane_b32 s80, v4
    s_cmp_ge_u32 s80, 11
    s_cbranch_scc1 WD_32
    s_sleep 1
    s_sub_u32 s99, s99, 1
    s_cmp_lg_u32 s99, 0
    s_cbranch_scc1 W_31
WD_32:
SW_33:
    s_add_u32 m0, s9, 0
    s_nop 0
    buffer_load_dwordx4 v12, s[56:59], s8 offen lds
    s_add_u32 m0, s9, 3072
    s_nop 0
    buffer_load_dwordx4 v13, s[56:59], s8 offen lds
    s_add_u32 m0, s9, 6144
    s_nop 0
    buffer_load_dwordx4 v14, s[56:59], s8 offen lds
    s_add_u32 s9, s9, 9216
    s_add_u32 s8, s8, 73728
    s_cmp_lt_u32 s9, 27904
    s_cbranch_scc1 SW_33
    s_waitcnt vmcnt(0)
    s_mov_b64 exec, 1
    ds_add_u32 v2, v3 offset:112
    s_mov_b64 exec, -1
    s_mov_b32 s99, 0x80000
W_34:
    ds_read_b32 v4, v2 offset:4
    s_waitcnt lgkmcnt(0)
    v_readfirstlane_b32 s80, v4
    s_cmp_ge_u32 s80, 1
    s_cbranch_scc1 WD_35
    s_sleep 1
    s_sub_u32 s99, s99, 1
    s_cmp_lg_u32 s99, 0
    s_cbranch_scc1 W_34
WD_35:
SW_36:
    s_add_u32 m0, s9, 0
    s_nop 0
    buffer_load_dwordx4 v12, s[56:59], s8 offen lds
    s_add_u32 m0, s9, 3072
    s_nop 0
    buffer_load_dwordx4 v13, s[56:59], s8 offen lds
    s_add_u32 m0, s9, 6144
    s_nop 0
    buffer_load_dwordx4 v14, s[56:59], s8 offen lds
    s_add_u32 s9, s9, 9216
    s_add_u32 s8, s8, 73728
    s_cmp_lt_u32 s9, 83200
    s_cbranch_scc1 SW_36
    s_waitcnt vmcnt(9)
    s_mov_b64 exec, 1
    ds_add_u32 v2, v3 offset:116
    s_mov_b64 exec, -1
    s_waitcnt vmcnt(0)
    s_mov_b64 exec, 1
    ds_add_u32 v2, v3 offset:120
    s_mov_b64 exec, -1
M_LD2:
    s_mov_b32 s83, 0x40000
    s_mov_b64 exec, 1
PL_37:
    buffer_load_dword v4, v2, s[72:75], 0 offen offset:128 sc1
    s_waitcnt vmcnt(0)
    v_readfirstlane_b32 s80, v4
    s_cmp_eq_u32 s80, 1
    s_cbranch_scc1 PD_38
    s_sub_u32 s83, s83, 1
    s_cmp_eq_u32 s83, 0
    s_cbranch_scc1 PD_38
    s_sleep 2
    s_branch PL_37
PD_38:
    s_mov_b64 exec, -1
    s_mov_b32 s99, 0x80000
W_39:
    ds_read_b32 v4, v2 offset:24
    s_waitcnt lgkmcnt(0)
    v_readfirstlane_b32 s80, v4
    s_cmp_ge_u32 s80, 8
    s_cbranch_scc1 WD_40
    s_sleep 1
    s_sub_u32 s99, s99, 1
    s_cmp_lg_u32 s99, 0
    s_cbranch_scc1 W_39
WD_40:
    s_mov_b32 s84, 2490368
    s_mov_b32 s85, 256
    v_mov_b32 v11, 8
DL_41:
    s_mov_b32 m0, s85
    s_add_u32 s85, s85, 1024
    buffer_load_dwordx4 v9, s[68:71], s84 offen sc1 lds
    s_add_u32 s84, s84, 1024
    s_cmp_lt_u32 s85, 20736
    s_cbranch_scc1 DL_41
    s_mov_b32 s99, 0x80000
W_42:
    ds_read_b32 v4, v2 offset:12
    s_waitcnt lgkmcnt(0)
    v_readfirstlane_b32 s80, v4
    s_cmp_ge_u32 s80, 8
    s_cbranch_scc1 WD_43
    s_sleep 1
    s_sub_u32 s99, s99, 1
    s_cmp_lg_u32 s99, 0
    s_cbranch_scc1 W_42
WD_43:
    s_mov_b64 exec, 1
    ds_add_u32 v2, v3 offset:16
    s_mov_b64 exec, -1
    s_waitcnt vmcnt(0)
    s_mov_b64 exec, 1
    ds_write_b32 v2, v11 offset:32
    s_mov_b64 exec, -1
    s_mov_b32 s83, 0x40000
    s_mov_b64 exec, 1
PL_44:
    buffer_load_dword v4, v2, s[72:75], 0 offen offset:132 sc1
    s_waitcnt vmcnt(0)
    v_readfirstlane_b32 s80, v4
    s_cmp_eq_u32 s80, 1
    s_cbranch_scc1 PD_45
    s_sub_u32 s83, s83, 1
    s_cmp_eq_u32 s83, 0
    s_cbranch_scc1 PD_45
    s_sleep 2
    s_branch PL_44
PD_45:
    s_mov_b64 exec, -1
    s_mov_b64 exec, 1
    ds_add_u32 v2, v3 offset:28
    s_mov_b64 exec, -1
    s_cmp_lt_u32 s78, 2
    s_cbranch_scc1 LD_NOU
    s_mov_b32 s99, 0x80000
W_46:
    ds_read_b32 v4, v2 offset:20
    s_waitcnt lgkmcnt(0)
    v_readfirstlane_b32 s80, v4
    s_cmp_ge_u32 s80, 1
    s_cbranch_scc1 WD_47
    s_sleep 1
    s_sub_u32 s99, s99, 1
    s_cmp_lg_u32 s99, 0
    s_cbranch_scc1 W_46
WD_47:
    s_lshl_b32 s81, s78, 7
    s_add_u32 s81, s81, 8328960
    s_mov_b64 exec, 1
    v_mov_b32 v4, 1
    buffer_atomic_add v4, v2, s[68:71], s81 offen sc0
    s_waitcnt vmcnt(0)
    v_readfirstlane_b32 s80, v4
    s_cmp_lg_u32 s80, 31
    s_cbranch_scc1 LD_U3
    buffer_store_dword v3, v2, s[68:71], s81 offen offset:1024 sc1
LD_U3:
    s_mov_b64 exec, -1
LD_NOU:
    s_mov_b32 s84, 2551808
    s_mov_b32 s90, 3
    v_mov_b32 v10, 0
    v_mov_b32 v11, 8
    s_mov_b32 s85, 256
LD_LOOP:
    s_mov_b32 s99, 0x80000
W_48:
    ds_read_b32 v4, v10 offset:72
    s_waitcnt lgkmcnt(0)
    v_readfirstlane_b32 s80, v4
    s_cmp_ge_u32 s80, 8
    s_cbranch_scc1 WD_49
    s_sleep 4
    s_sub_u32 s99, s99, 1
    s_cmp_lg_u32 s99, 0
    s_cbranch_scc1 W_48
WD_49:
    s_lshl_b32 s84, s90, 1
    s_and_b32 s84, s84, 7
    s_lshr_b32 s86, s90, 2
    s_add_u32 s84, s84, s86
    s_mul_i32 s84, s84, 20480
    s_add_u32 s84, s84, 2490368
    s_mov_b32 s86, 20
FL_50:
    s_mov_b32 m0, s85
    s_add_u32 s85, s85, 1024
    buffer_load_dwordx4 v9, s[68:71], s84 offen sc1 lds
    s_add_u32 s84, s84, 1024
    s_sub_u32 s86, s86, 1
    s_cmp_lg_u32 s86, 0
    s_cbranch_scc1 FL_50
    s_cmp_ge_u32 s85, 61696
    s_cselect_b32 s85, 256, s85
    s_waitcnt vmcnt(0)
    s_mov_b64 exec, 1
    ds_write_b32 v10, v11 offset:44
    s_mov_b64 exec, -1
    v_add_u32 v10, 4, v10
    s_add_u32 s90, s90, 1
    s_cmp_lt_u32 s90, 8
    s_cbranch_scc1 LD_LOOP
    s_mov_b32 s99, 0x80000
W_51:
    ds_read_b32 v4, v2 offset:92
    s_waitcnt lgkmcnt(0)
    v_readfirstlane_b32 s80, v4
    s_cmp_ge_u32 s80, 8
    s_cbranch_scc1 WD_52
    s_sleep 4
    s_sub_u32 s99, s99, 1
    s_cmp_lg_u32 s99, 0
    s_cbranch_scc1 W_51
WD_52:
    s_mov_b32 s99, 0x80000
W_53:
    ds_read_b32 v4, v2 offset:136
    s_waitcnt lgkmcnt(0)
    v_readfirstlane_b32 s80, v4
    s_cmp_ge_u32 s80, s87
    s_cbranch_scc1 WD_54
    s_sleep 4
    s_sub_u32 s99, s99, 1
    s_cmp_lg_u32 s99, 0
    s_cbranch_scc1 W_53
WD_54:
    s_lshl_b32 s84, s77, 10
    s_add_u32 s84, s84, 8331264
    s_lshl_b32 s80, s78, 2
    v_lshlrev_b32 v12, 7, v1
    v_add_u32 v12, s80, v12
    s_lshl_b32 s80, s78, 7
    v_lshlrev_b32 v10, 2, v1
    v_add_u32 v10, s80, v10
    s_mov_b32 s85, 0
    s_mov_b32 s90, 0
    s_mov_b32 s83, 0x40000
    s_mov_b32 s87, 0
    s_mov_b32 s88, 0
    s_lshl_b32 s89, 0x101, s78
    s_mov_b64 exec, 0xffff
LC_LOOP:
    ds_read_b64 v[6:7], v2 offset:128
    ds_read_b32 v5, v2 offset:96
    s_waitcnt lgkmcnt(0)
    v_cmp_le_u32 vcc, 8, v5
    s_and_b32 s86, vcc_lo, 0x0f00
    s_or_b32 s86, s86, 0xff
    v_cmp_le_u32 vcc, 4, v6
    s_and_b32 s80, vcc_lo, 0x00ff
    v_cmp_le_u32 vcc, 4, v7
    s_and_b32 s81, vcc_lo, 0xff00
    s_or_b32 s82, s80, s81
    s_cmp_eq_u32 s82, 0xffff
    s_cselect_b32 s86, s82, s86
    s_and_b32 s80, s82, s89
    s_mov_b32 s85, s80
    s_or_b32 s80, s87, s85
    s_and_b32 s80, s80, s86
    s_and_b32 s81, s80, 0xff
    s_cmp_eq_u32 s81, 0xff
    s_cselect_b32 s81, 1, 0
    v_mov_b32 v6, s81
    s_lshr_b32 s81, s80, 8
    s_cmp_eq_u32 s81, 0xff
    s_cselect_b32 s81, 1, 0
    v_mov_b32 v7, s81
    ds_write_b64 v2, v[6:7] offset:144
    s_cmp_eq_u32 s80, 0xffff
    s_cbranch_scc1 LC_END
    s_sub_u32 s83, s83, 1
    s_cmp_eq_u32 s83, 0
    s_cbranch_scc1 LC_END
    s_cmp_eq_u32 s88, 0
    s_cbranch_scc1 LC_POLL
    s_sub_u32 s88, s88, 1
    s_sleep 1
    s_branch LC_LOOP
LC_POLL:
    buffer_load_dword v4, v10, s[68:71], s84 offen sc1
    s_cmp_eq_u32 s85, 0
    s_cselect_b32 s88, 3, 0
    s_waitcnt vmcnt(0)
    v_cmp_eq_u32 vcc, 1, v4
    s_and_b32 s87, vcc_lo, 0xffff
    s_branch LC_LOOP
LC_END:
    s_mov_b64 exec, -1
    s_waitcnt vmcnt(0) lgkmcnt(0)
    s_endpgm
M_SSM:
    s_sub_u32 s51, s76, 8
    s_lshl_b32 s50, s78, 5
    s_add_u32 s50, s50, s77
    s_sub_u32 s50, s50, 64
    s_mul_i32 s50, s50, 3
    s_add_u32 s90, s50, s51
    s_mul_i32 s92, s51, 17152
    s_add_u32 s92, s92, 63232
    s_lshl_b32 s91, s51, 14
    s_sub_u32 s91, 147456, s91
    s_waitcnt lgkmcnt(0)
    s_barrier
    s_mov_b32 s68, s48
    s_and_b32 s69, s49, 0xffff
    s_mov_b32 s70, 8388608
    s_mov_b32 s71, 0x00020000
    s_mov_b32 s72, s46
    s_and_b32 s73, s47, 0xffff
    s_mov_b32 s74, 256
    s_mov_b32 s75, 0x00020000
    s_cmp_ge_u32 s78, 2
    s_cbranch_scc1 S_GO
    s_cmp_eq_u32 s78, 0
    s_cselect_b32 s60, s38, s40
    s_cselect_b32 s61, s39, s41
    s_and_b32 s61, s61, 0xffff
    s_mov_b32 s62, 20736
    s_mov_b32 s63, 0x00020000
    s_lshl_b32 s80, s51, 6
    v_add_u32 v4, s80, v1
    v_mul_u32_u24 v5, 21846, v4
    v_lshrrev_b32 v5, 16, v5
    v_mul_u32_u24 v6, 3, v5
    v_sub_u32 v6, v4, v6
    v_and_b32 v4, 1, v5
    v_bfe_u32 v7, v5, 1, 2
    v_lshl_add_u32 v4, v4, 2, v7
    v_and_b32 v5, 0xf8, v5
    v_add_u32 v5, v5, v4
    v_mul_u32_u24 v4, 36, v5
    v_lshl_add_u32 v4, v6, 4, v4
    s_lshl_b32 s81, s51, 10
    s_add_u32 s81, s81, 55552
    s_mov_b32 s80, 0
DL_55:
    s_mov_b32 m0, s81
    s_add_u32 s81, s81, 3072
    buffer_load_dwordx4 v4, s[60:63], s80 offen  lds
    s_add_u32 s80, s80, 2304
    s_cmp_lt_u32 s81, 83200
    s_cbranch_scc1 DL_55
    s_waitcnt vmcnt(0)
    s_mov_b64 exec, 1
    ds_add_u32 v2, v3 offset:0
    s_mov_b64 exec, -1
    s_cmp_eq_u32 s51, 2
    s_cbranch_scc1 S_PUB
    s_mov_b32 s56, s36
    s_and_b32 s57, s37, 0xffff
    s_mov_b32 s58, 663552
    s_mov_b32 s59, 0x00020000
    s_sub_u32 s79, s76, 8
    s_min_u32 s79, s79, 2
    s_add_u32 s83, s79, 0
    s_lshl_b32 s80, s83, 6
    v_add_u32 v4, s80, v1
    v_mul_u32_u24 v5, 7282, v4
    v_lshrrev_b32 v5, 16, v5
    v_mul_u32_u24 v6, 9, v5
    v_sub_u32 v6, v4, v6
    v_and_b32 v4, 3, v5
    v_bfe_u32 v7, v5, 2, 2
    v_lshl_add_u32 v4, v4, 2, v7
    v_and_b32 v5, 0x30, v5
    v_add_u32 v5, v5, v4
    v_mul_u32_u24 v4, 1152, v5
    v_lshl_add_u32 v12, v6, 4, v4
    s_add_u32 s83, s79, 3
    s_lshl_b32 s80, s83, 6
    v_add_u32 v4, s80, v1
    v_mul_u32_u24 v5, 7282, v4
    v_lshrrev_b32 v5, 16, v5
    v_mul_u32_u24 v6, 9, v5
    v_sub_u32 v6, v4, v6
    v_and_b32 v4, 3, v5
    v_bfe_u32 v7, v5, 2, 2
    v_lshl_add_u32 v4, v4, 2, v7
    v_and_b32 v5, 0x30, v5
    v_add_u32 v5, v5, v4
    v_mul_u32_u24 v4, 1152, v5
    v_lshl_add_u32 v13, v6, 4, v4
    s_add_u32 s83, s79, 6
    s_lshl_b32 s80, s83, 6
    v_add_u32 v4, s80, v1
    v_mul_u32_u24 v5, 7282, v4
    v_lshrrev_b32 v5, 16, v5
    v_mul_u32_u24 v6, 9, v5
    v_sub_u32 v6, v4, v6
    v_and_b32 v4, 3, v5
    v_bfe_u32 v7, v5, 2, 2
    v_lshl_add_u32 v4, v4, 2, v7
    v_and_b32 v5, 0x30, v5
    v_add_u32 v5, v5, v4
    v_mul_u32_u24 v4, 1152, v5
    v_lshl_add_u32 v14, v6, 4, v4
    s_mul_i32 s8, s78, 144
    s_lshl_b32 s9, s79, 10
    s_add_u32 s9, s9, 256
    s_mov_b32 s99, 0x80000
W_56:
    ds_read_b32 v4, v2 offset:0
    s_waitcnt lgkmcnt(0)
    v_readfirstlane_b32 s80, v4
    s_cmp_ge_u32 s80, 11
    s_cbranch_scc1 WD_57
    s_sleep 1
    s_sub_u32 s99, s99, 1
    s_cmp_lg_u32 s99, 0
    s_cbranch_scc1 W_56
WD_57:
SW_58:
    s_add_u32 m0, s9, 0
    s_nop 0
    buffer_load_dwordx4 v12, s[56:59], s8 offen lds
    s_add_u32 m0, s9, 3072
    s_nop 0
    buffer_load_dwordx4 v13, s[56:59], s8 offen lds
    s_add_u32 m0, s9, 6144
    s_nop 0
    buffer_load_dwordx4 v14, s[56:59], s8 offen lds
    s_add_u32 s9, s9, 9216
    s_add_u32 s8, s8, 73728
    s_cmp_lt_u32 s9, 27904
    s_cbranch_scc1 SW_58
    s_waitcnt vmcnt(0)
    s_mov_b64 exec, 1
    ds_add_u32 v2, v3 offset:112
    s_mov_b64 exec, -1
    s_mov_b32 s99, 0x80000
W_59:
    ds_read_b32 v4, v2 offset:4
    s_waitcnt lgkmcnt(0)
    v_readfirstlane_b32 s80, v4
    s_cmp_ge_u32 s80, 1
    s_cbranch_scc1 WD_60
    s_sleep 1
    s_sub_u32 s99, s99, 1
    s_cmp_lg_u32 s99, 0
    s_cbranch_scc1 W_59
WD_60:
SW_61:
    s_add_u32 m0, s9, 0
    s_nop 0
    buffer_load_dwordx4 v12, s[56:59], s8 offen lds
    s_add_u32 m0, s9, 3072
    s_nop 0
    buffer_load_dwordx4 v13, s[56:59], s8 offen lds
    s_add_u32 m0, s9, 6144
    s_nop 0
    buffer_load_dwordx4 v14, s[56:59], s8 offen lds
    s_add_u32 s9, s9, 9216
    s_add_u32 s8, s8, 73728
    s_cmp_lt_u32 s9, 83200
    s_cbranch_scc1 SW_61
    s_waitcnt vmcnt(9)
    s_mov_b64 exec, 1
    ds_add_u32 v2, v3 offset:116
    s_mov_b64 exec, -1
    s_waitcnt vmcnt(0)
    s_mov_b64 exec, 1
    ds_add_u32 v2, v3 offset:120
    s_mov_b64 exec, -1
    s_branch S_PW
S_PUB:
    s_lshl_b32 s81, s78, 5
    s_add_u32 s81, s81, s77
    s_lshl_b32 s81, s81, 7
    s_add_u32 s81, s81, 8323072
    v_lshlrev_b32 v4, 2, v1
    s_mov_b64 exec, 1
    buffer_store_dword v2, v4, s[68:71], s81 offen sc1
    s_mov_b64 exec, -1
    s_lshl_b32 s81, s77, 1
    s_add_u32 s81, s81, s78
    s_lshl_b32 s81, s81, 9
    s_add_u32 s81, s81, 8331264
    v_lshrrev_b32 v4, 4, v1
    v_lshlrev_b32 v4, 7, v4
    v_and_b32 v5, 15, v1
    v_lshl_add_u32 v4, v5, 2, v4
    buffer_store_dword v2, v4, s[68:71], s81 offen sc1
    s_mov_b32 s99, 0x80000
W_62:
    ds_read_b32 v4, v2 offset:8
    s_waitcnt lgkmcnt(0)
    v_readfirstlane_b32 s80, v4
    s_cmp_ge_u32 s80, 8
    s_cbranch_scc1 WD_63
    s_sleep 1
    s_sub_u32 s99, s99, 1
    s_cmp_lg_u32 s99, 0
    s_cbranch_scc1 W_62
WD_63:
    s_waitcnt vmcnt(0)
    s_mov_b64 exec, 1
    v_mov_b32 v4, 1
    s_and_b32 s81, s77, 4
    buffer_atomic_add v4, v2, s[72:75], s81 offen sc0
    s_waitcnt vmcnt(0)
    v_readfirstlane_b32 s80, v4
    s_cmp_lg_u32 s80, 31
    s_cbranch_scc1 S_PUBX
    buffer_store_dword v3, v2, s[72:75], s81 offen offset:128 sc1
S_PUBX:
    ds_write_b32 v2, v3 offset:4
    s_mov_b64 exec, -1
    s_endpgm
S_PW:
    s_mov_b32 s79, 0
    s_mov_b32 s99, 0x80000
W_64:
    ds_read_b32 v4, v2 offset:40
    s_waitcnt lgkmcnt(0)
    v_readfirstlane_b32 s80, v4
    s_cmp_ge_u32 s80, 8
    s_cbranch_scc1 WD_65
    s_sleep 8
    s_sub_u32 s99, s99, 1
    s_cmp_lg_u32 s99, 0
    s_cbranch_scc1 W_64
WD_65:
    s_mov_b32 s99, 0x80000
W_66:
    ds_read_b32 v4, v2 offset:28
    s_waitcnt lgkmcnt(0)
    v_readfirstlane_b32 s80, v4
    s_cmp_ge_u32 s80, 1
    s_cbranch_scc1 WD_67
    s_sleep 8
    s_sub_u32 s99, s99, 1
    s_cmp_lg_u32 s99, 0
    s_cbranch_scc1 W_66
WD_67:
    s_branch S_WO
S_GO:
    s_setprio 3
    s_lshl_b32 s80, s90, 8
    v_lshlrev_b32 v4, 2, v1
    v_add_u32 v4, s80, v4
    s_lshl_b32 s80, s90, 1
    v_mov_b32 v5, s80
    global_load_dword v8, v4, s[18:19]
    global_load_dword v9, v4, s[20:21]
    global_load_dword v10, v4, s[22:23]
    global_load_dword v11, v4, s[24:25]
    global_load_dword v12, v4, s[26:27]
    global_load_dword v13, v4, s[28:29]
    global_load_ushort v14, v5, s[30:31]
    global_load_ushort v15, v5, s[32:33]
    s_nop 0
    s_cmp_eq_u32 s51, 2
    s_cbranch_scc1 S_NOW
    s_mov_b32 s56, s36
    s_and_b32 s57, s37, 0xffff
    s_mov_b32 s58, 663552
    s_mov_b32 s59, 0x00020000
    s_sub_u32 s79, s76, 8
    s_min_u32 s79, s79, 2
    s_add_u32 s83, s79, 0
    s_lshl_b32 s80, s83, 6
    v_add_u32 v4, s80, v1
    v_mul_u32_u24 v5, 7282, v4
    v_lshrrev_b32 v5, 16, v5
    v_mul_u32_u24 v6, 9, v5
    v_sub_u32 v6, v4, v6
    v_and_b32 v4, 3, v5
    v_bfe_u32 v7, v5, 2, 2
    v_lshl_add_u32 v4, v4, 2, v7
    v_and_b32 v5, 0x30, v5
    v_add_u32 v5, v5, v4
    v_mul_u32_u24 v4, 1152, v5
    v_lshl_add_u32 v16, v6, 4, v4
    s_add_u32 s83, s79, 3
    s_lshl_b32 s80, s83, 6
    v_add_u32 v4, s80, v1
    v_mul_u32_u24 v5, 7282, v4
    v_lshrrev_b32 v5, 16, v5
    v_mul_u32_u24 v6, 9, v5
    v_sub_u32 v6, v4, v6
    v_and_b32 v4, 3, v5
    v_bfe_u32 v7, v5, 2, 2
    v_lshl_add_u32 v4, v4, 2, v7
    v_and_b32 v5, 0x30, v5
    v_add_u32 v5, v5, v4
    v_mul_u32_u24 v4, 1152, v5
    v_lshl_add_u32 v17, v6, 4, v4
    s_add_u32 s83, s79, 6
    s_lshl_b32 s80, s83, 6
    v_add_u32 v4, s80, v1
    v_mul_u32_u24 v5, 7282, v4
    v_lshrrev_b32 v5, 16, v5
    v_mul_u32_u24 v6, 9, v5
    v_sub_u32 v6, v4, v6
    v_and_b32 v4, 3, v5
    v_bfe_u32 v7, v5, 2, 2
    v_lshl_add_u32 v4, v4, 2, v7
    v_and_b32 v5, 0x30, v5
    v_add_u32 v5, v5, v4
    v_mul_u32_u24 v4, 1152, v5
    v_lshl_add_u32 v18, v6, 4, v4
    s_mul_i32 s8, s78, 144
    s_lshl_b32 s9, s79, 10
    s_add_u32 s9, s9, 256
SW_68:
    s_add_u32 m0, s9, 0
    s_nop 0
    buffer_load_dwordx4 v16, s[56:59], s8 offen lds
    s_add_u32 m0, s9, 3072
    s_nop 0
    buffer_load_dwordx4 v17, s[56:59], s8 offen lds
    s_add_u32 m0, s9, 6144
    s_nop 0
    buffer_load_dwordx4 v18, s[56:59], s8 offen lds
    s_add_u32 s9, s9, 9216
    s_add_u32 s8, s8, 73728
    s_cmp_lt_u32 s9, 55552
    s_cbranch_scc1 SW_68
    s_waitcnt vmcnt(9)
    s_mov_b64 exec, 1
    ds_add_u32 v2, v3 offset:112
    s_mov_b64 exec, -1
SW_69:
    s_add_u32 m0, s9, 0
    s_nop 0
    buffer_load_dwordx4 v16, s[56:59], s8 offen lds
    s_add_u32 m0, s9, 3072
    s_nop 0
    buffer_load_dwordx4 v17, s[56:59], s8 offen lds
    s_add_u32 m0, s9, 6144
    s_nop 0
    buffer_load_dwordx4 v18, s[56:59], s8 offen lds
    s_add_u32 s9, s9, 9216
    s_add_u32 s8, s8, 73728
    s_cmp_lt_u32 s9, 83200
    s_cbranch_scc1 SW_69
    s_waitcnt vmcnt(9)
    s_mov_b64 exec, 1
    ds_add_u32 v2, v3 offset:116
    s_mov_b64 exec, -1
    s_waitcnt vmcnt(0)
    s_mov_b64 exec, 1
    ds_add_u32 v2, v3 offset:120
    s_mov_b64 exec, -1
S_NOW:
    s_mov_b32 s79, 3
    v_cmp_eq_u32 vcc, 0, v1
    s_waitcnt vmcnt(0)
    v_lshlrev_b32 v14, 16, v14
    v_mul_f32 v14, 0x3fb8aa3b, v14
    v_exp_f32 v14, v14
    v_lshlrev_b32 v15, 16, v15
    v_cvt_pk_bf16_f32 v14, v14, v14
    v_lshlrev_b32 v14, 16, v14
    v_cndmask_b32 v15, 0, v15, vcc
    v_lshlrev_b32 v54, 16, v8
    v_lshlrev_b32 v55, 16, v9
    v_lshlrev_b32 v56, 16, v10
    v_lshlrev_b32 v57, 16, v11
    v_lshlrev_b32 v58, 16, v12
    v_lshlrev_b32 v59, 16, v13
    v_mul_f32 v60, v54, v14
    v_mul_f32 v61, v55, v14
    v_mul_f32 v60, 0x3fb8aa3b, v60
    v_mul_f32 v61, 0.15915494, v61
    v_mul_f32 v62, v59, v57
    v_mul_f32 v63, v59, v56
    v_fma_f32 v30, v58, v56, -v62
    v_fma_f32 v31, v58, v57, v63
    v_mul_f32 v30, v30, v14
    v_mul_f32 v31, v31, v14
    v_mul_f32 v62, 0x3f800000, v60
    v_mul_f32 v63, 0x3f800000, v61
    v_mul_f32 v64, 0x41000000, v60
    v_mul_f32 v65, 0x41000000, v61
    v_mul_f32 v66, 0x43800000, v60
    v_mul_f32 v67, 0x43800000, v61
    v_exp_f32 v62, v62
    v_fract_f32 v63, v63
    v_exp_f32 v64, v64
    v_fract_f32 v65, v65
    v_exp_f32 v66, v66
    v_fract_f32 v67, v67
    v_cos_f32 v24, v63
    v_sin_f32 v25, v63
    v_cos_f32 v26, v65
    v_sin_f32 v27, v65
    v_cos_f32 v28, v67
    v_sin_f32 v29, v67
    s_nop 0
    v_mul_f32 v24, v24, v62
    v_mul_f32 v25, v25, v62
    v_mul_f32 v26, v26, v64
    v_mul_f32 v27, v27, v64
    v_mul_f32 v28, v28, v66
    v_mul_f32 v29, v29, v66
    v_mov_b32 v38, 1.0
    v_mov_b32 v39, 0
    v_mov_b32 v40, v26
    v_mov_b32 v41, v27
    v_pk_mul_f32 v[16:17], v[26:27], v[26:27] op_sel:[1,1] op_sel_hi:[1,0] neg_lo:[1,0]
    v_pk_mul_f32 v[18:19], v[24:25], v[24:25] op_sel:[1,1] op_sel_hi:[1,0] neg_lo:[1,0]
    v_pk_mul_f32 v[20:21], v[30:31], v[24:25] op_sel:[1,1] op_sel_hi:[1,0] neg_lo:[1,0]
    v_pk_mul_f32 v[22:23], v[30:31], v[26:27] op_sel:[1,1] op_sel_hi:[1,0] neg_lo:[1,0]
    v_pk_fma_f32 v[42:43], v[26:27], v[26:27], v[16:17] op_sel:[0,0,0] op_sel_hi:[0,1,1]
    v_pk_fma_f32 v[32:33], v[24:25], v[24:25], v[18:19] op_sel:[0,0,0] op_sel_hi:[0,1,1]
    v_pk_fma_f32 v[54:55], v[30:31], v[24:25], v[20:21] op_sel:[0,0,0] op_sel_hi:[0,1,1]
    v_pk_fma_f32 v[68:69], v[30:31], v[26:27], v[22:23] op_sel:[0,0,0] op_sel_hi:[0,1,1]
    v_pk_mul_f32 v[16:17], v[42:43], v[26:27] op_sel:[1,1] op_sel_hi:[1,0] neg_lo:[1,0]
    v_pk_mul_f32 v[18:19], v[42:43], v[42:43] op_sel:[1,1] op_sel_hi:[1,0] neg_lo:[1,0]
    v_pk_mul_f32 v[20:21], v[32:33], v[32:33] op_sel:[1,1] op_sel_hi:[1,0] neg_lo:[1,0]
    v_pk_mul_f32 v[22:23], v[30:31], v[32:33] op_sel:[1,1] op_sel_hi:[1,0] neg_lo:[1,0]
    v_pk_fma_f32 v[44:45], v[42:43], v[26:27], v[16:17] op_sel:[0,0,0] op_sel_hi:[0,1,1]
    v_pk_fma_f32 v[46:47], v[42:43], v[42:43], v[18:19] op_sel:[0,0,0] op_sel_hi:[0,1,1]
    v_pk_fma_f32 v[34:35], v[32:33], v[32:33], v[20:21] op_sel:[0,0,0] op_sel_hi:[0,1,1]
    v_pk_fma_f32 v[56:57], v[30:31], v[32:33], v[22:23] op_sel:[0,0,0] op_sel_hi:[0,1,1]
    v_pk_mul_f32 v[16:17], v[54:55], v[32:33] op_sel:[1,1] op_sel_hi:[1,0] neg_lo:[1,0]
    v_pk_fma_f32 v[58:59], v[54:55], v[32:33], v[16:17] op_sel:[0,0,0] op_sel_hi:[0,1,1]
    v_pk_mul_f32 v[18:19], v[46:47], v[26:27] op_sel:[1,1] op_sel_hi:[1,0] neg_lo:[1,0]
    v_pk_mul_f32 v[20:21], v[46:47], v[42:43] op_sel:[1,1] op_sel_hi:[1,0] neg_lo:[1,0]
    v_pk_mul_f32 v[22:23], v[46:47], v[44:45] op_sel:[1,1] op_sel_hi:[1,0] neg_lo:[1,0]
    v_pk_mul_f32 v[16:17], v[46:47], v[46:47] op_sel:[1,1] op_sel_hi:[1,0] neg_lo:[1,0]
    v_pk_fma_f32 v[48:49], v[46:47], v[26:27], v[18:19] op_sel:[0,0,0] op_sel_hi:[0,1,1]
    v_pk_fma_f32 v[50:51], v[46:47], v[42:43], v[20:21] op_sel:[0,0,0] op_sel_hi:[0,1,1]
    v_pk_fma_f32 v[52:53], v[46:47], v[44:45], v[22:23] op_sel:[0,0,0] op_sel_hi:[0,1,1]
    v_pk_fma_f32 v[36:37], v[46:47], v[46:47], v[16:17] op_sel:[0,0,0] op_sel_hi:[0,1,1]
    v_pk_mul_f32 v[18:19], v[30:31], v[34:35] op_sel:[1,1] op_sel_hi:[1,0] neg_lo:[1,0]
    v_pk_mul_f32 v[20:21], v[54:55], v[34:35] op_sel:[1,1] op_sel_hi:[1,0] neg_lo:[1,0]
    v_pk_mul_f32 v[22:23], v[56:57], v[34:35] op_sel:[1,1] op_sel_hi:[1,0] neg_lo:[1,0]
    v_pk_mul_f32 v[16:17], v[58:59], v[34:35] op_sel:[1,1] op_sel_hi:[1,0] neg_lo:[1,0]
    v_pk_fma_f32 v[60:61], v[30:31], v[34:35], v[18:19] op_sel:[0,0,0] op_sel_hi:[0,1,1]
    v_pk_fma_f32 v[62:63], v[54:55], v[34:35], v[20:21] op_sel:[0,0,0] op_sel_hi:[0,1,1]
    v_pk_fma_f32 v[64:65], v[56:57], v[34:35], v[22:23] op_sel:[0,0,0] op_sel_hi:[0,1,1]
    v_pk_fma_f32 v[66:67], v[58:59], v[34:35], v[16:17] op_sel:[0,0,0] op_sel_hi:[0,1,1]
    v_cvt_pk_bf16_f32 v120, v38, v40
    v_cvt_pk_bf16_f32 v124, v39, v41
    v_cvt_pk_bf16_f32 v121, v42, v44
    v_cvt_pk_bf16_f32 v125, v43, v45
    v_cvt_pk_bf16_f32 v122, v46, v48
    v_cvt_pk_bf16_f32 v126, v47, v49
    v_cvt_pk_bf16_f32 v123, v50, v52
    v_cvt_pk_bf16_f32 v127, v51, v53
    v_cvt_pk_bf16_f32 v88, v30, v54
    v_cvt_pk_bf16_f32 v92, -v31, -v55
    v_cvt_pk_bf16_f32 v89, v56, v58
    v_cvt_pk_bf16_f32 v93, -v57, -v59
    v_cvt_pk_bf16_f32 v90, v60, v62
    v_cvt_pk_bf16_f32 v94, -v61, -v63
    v_cvt_pk_bf16_f32 v91, v64, v66
    v_cvt_pk_bf16_f32 v95, -v65, -v67
    v_pk_mul_f32 v[18:19], v[30:31], v[28:29] op_sel:[1,1] op_sel_hi:[1,0] neg_lo:[1,0]
    v_pk_mul_f32 v[20:21], v[56:57], v[28:29] op_sel:[1,1] op_sel_hi:[1,0] neg_lo:[1,0]
    v_pk_mul_f32 v[22:23], v[60:61], v[28:29] op_sel:[1,1] op_sel_hi:[1,0] neg_lo:[1,0]
    v_pk_mul_f32 v[16:17], v[64:65], v[28:29] op_sel:[1,1] op_sel_hi:[1,0] neg_lo:[1,0]
    v_pk_fma_f32 v[30:31], v[30:31], v[28:29], v[18:19] op_sel:[0,0,0] op_sel_hi:[0,1,1]
    v_pk_fma_f32 v[56:57], v[56:57], v[28:29], v[20:21] op_sel:[0,0,0] op_sel_hi:[0,1,1]
    v_pk_fma_f32 v[60:61], v[60:61], v[28:29], v[22:23] op_sel:[0,0,0] op_sel_hi:[0,1,1]
    v_pk_fma_f32 v[64:65], v[64:65], v[28:29], v[16:17] op_sel:[0,0,0] op_sel_hi:[0,1,1]
    v_pk_mul_f32 v[18:19], v[68:69], v[28:29] op_sel:[1,1] op_sel_hi:[1,0] neg_lo:[1,0]
    v_pk_mul_f32 v[20:21], v[38:39], v[36:37] op_sel:[1,1] op_sel_hi:[1,0] neg_lo:[1,0]
    v_pk_mul_f32 v[22:23], v[40:41], v[36:37] op_sel:[1,1] op_sel_hi:[1,0] neg_lo:[1,0]
    v_pk_mul_f32 v[16:17], v[42:43], v[36:37] op_sel:[1,1] op_sel_hi:[1,0] neg_lo:[1,0]
    v_pk_fma_f32 v[68:69], v[68:69], v[28:29], v[18:19] op_sel:[0,0,0] op_sel_hi:[0,1,1]
    v_pk_fma_f32 v[38:39], v[38:39], v[36:37], v[20:21] op_sel:[0,0,0] op_sel_hi:[0,1,1]
    v_pk_fma_f32 v[40:41], v[40:41], v[36:37], v[22:23] op_sel:[0,0,0] op_sel_hi:[0,1,1]
    v_pk_fma_f32 v[42:43], v[42:43], v[36:37], v[16:17] op_sel:[0,0,0] op_sel_hi:[0,1,1]
    v_pk_mul_f32 v[18:19], v[44:45], v[36:37] op_sel:[1,1] op_sel_hi:[1,0] neg_lo:[1,0]
    v_pk_mul_f32 v[20:21], v[46:47], v[36:37] op_sel:[1,1] op_sel_hi:[1,0] neg_lo:[1,0]
    v_pk_mul_f32 v[22:23], v[48:49], v[36:37] op_sel:[1,1] op_sel_hi:[1,0] neg_lo:[1,0]
    v_pk_mul_f32 v[16:17], v[50:51], v[36:37] op_sel:[1,1] op_sel_hi:[1,0] neg_lo:[1,0]
    v_pk_fma_f32 v[44:45], v[44:45], v[36:37], v[18:19] op_sel:[0,0,0] op_sel_hi:[0,1,1]
    v_pk_fma_f32 v[46:47], v[46:47], v[36:37], v[20:21] op_sel:[0,0,0] op_sel_hi:[0,1,1]
    v_pk_fma_f32 v[48:49], v[48:49], v[36:37], v[22:23] op_sel:[0,0,0] op_sel_hi:[0,1,1]
    v_pk_fma_f32 v[50:51], v[50:51], v[36:37], v[16:17] op_sel:[0,0,0] op_sel_hi:[0,1,1]
    v_pk_mul_f32 v[18:19], v[52:53], v[36:37] op_sel:[1,1] op_sel_hi:[1,0] neg_lo:[1,0]
    v_pk_fma_f32 v[52:53], v[52:53], v[36:37], v[18:19] op_sel:[0,0,0] op_sel_hi:[0,1,1]
    v_cvt_pk_bf16_f32 v96, v30, v56
    v_cvt_pk_bf16_f32 v100, -v31, -v57
    v_cvt_pk_bf16_f32 v97, v60, 0
    v_cvt_pk_bf16_f32 v101, -v61, 0
    v_cvt_pk_bf16_f32 v98, v60, v64
    v_cvt_pk_bf16_f32 v102, -v61, -v65
    v_cvt_pk_bf16_f32 v99, v68, 0
    v_cvt_pk_bf16_f32 v103, -v69, 0
    v_cvt_pk_bf16_f32 v128, v38, v40
    v_cvt_pk_bf16_f32 v132, v39, v41
    v_cvt_pk_bf16_f32 v129, v42, v44
    v_cvt_pk_bf16_f32 v133, v43, v45
    v_cvt_pk_bf16_f32 v130, v46, v48
    v_cvt_pk_bf16_f32 v134, v47, v49
    v_cvt_pk_bf16_f32 v131, v50, v52
    v_cvt_pk_bf16_f32 v135, v51, v53
    v_pk_mul_f32 v[20:21], v[30:31], v[28:29] op_sel:[1,1] op_sel_hi:[1,0] neg_lo:[1,0]
    v_pk_mul_f32 v[22:23], v[60:61], v[28:29] op_sel:[1,1] op_sel_hi:[1,0] neg_lo:[1,0]
    v_pk_mul_f32 v[16:17], v[68:69], v[28:29] op_sel:[1,1] op_sel_hi:[1,0] neg_lo:[1,0]
    v_pk_mul_f32 v[18:19], v[38:39], v[36:37] op_sel:[1,1] op_sel_hi:[1,0] neg_lo:[1,0]
    v_pk_fma_f32 v[30:31], v[30:31], v[28:29], v[20:21] op_sel:[0,0,0] op_sel_hi:[0,1,1]
    v_pk_fma_f32 v[60:61], v[60:61], v[28:29], v[22:23] op_sel:[0,0,0] op_sel_hi:[0,1,1]
    v_pk_fma_f32 v[68:69], v[68:69], v[28:29], v[16:17] op_sel:[0,0,0] op_sel_hi:[0,1,1]
    v_pk_fma_f32 v[38:39], v[38:39], v[36:37], v[18:19] op_sel:[0,0,0] op_sel_hi:[0,1,1]
    v_pk_mul_f32 v[20:21], v[40:41], v[36:37] op_sel:[1,1] op_sel_hi:[1,0] neg_lo:[1,0]
    v_pk_mul_f32 v[22:23], v[42:43], v[36:37] op_sel:[1,1] op_sel_hi:[1,0] neg_lo:[1,0]
    v_pk_mul_f32 v[16:17], v[44:45], v[36:37] op_sel:[1,1] op_sel_hi:[1,0] neg_lo:[1,0]
    v_pk_mul_f32 v[18:19], v[46:47], v[36:37] op_sel:[1,1] op_sel_hi:[1,0] neg_lo:[1,0]
    v_pk_fma_f32 v[40:41], v[40:41], v[36:37], v[20:21] op_sel:[0,0,0] op_sel_hi:[0,1,1]
    v_pk_fma_f32 v[42:43], v[42:43], v[36:37], v[22:23] op_sel:[0,0,0] op_sel_hi:[0,1,1]
    v_pk_fma_f32 v[44:45], v[44:45], v[36:37], v[16:17] op_sel:[0,0,0] op_sel_hi:[0,1,1]
    v_pk_fma_f32 v[46:47], v[46:47], v[36:37], v[18:19] op_sel:[0,0,0] op_sel_hi:[0,1,1]
    v_cvt_pk_bf16_f32 v104, v30, v60
    v_cvt_pk_bf16_f32 v108, -v31, -v61
    v_cvt_pk_bf16_f32 v105, v68, 0
    v_cvt_pk_bf16_f32 v109, -v69, 0
    v_pk_mul_f32 v[20:21], v[30:31], v[28:29] op_sel:[1,1] op_sel_hi:[1,0] neg_lo:[1,0]
    v_pk_mul_f32 v[22:23], v[60:61], v[28:29] op_sel:[1,1] op_sel_hi:[1,0] neg_lo:[1,0]
    v_pk_mul_f32 v[16:17], v[68:69], v[28:29] op_sel:[1,1] op_sel_hi:[1,0] neg_lo:[1,0]
    v_pk_mul_f32 v[18:19], v[48:49], v[36:37] op_sel:[1,1] op_sel_hi:[1,0] neg_lo:[1,0]
    v_pk_fma_f32 v[30:31], v[30:31], v[28:29], v[20:21] op_sel:[0,0,0] op_sel_hi:[0,1,1]
    v_pk_fma_f32 v[60:61], v[60:61], v[28:29], v[22:23] op_sel:[0,0,0] op_sel_hi:[0,1,1]
    v_pk_fma_f32 v[68:69], v[68:69], v[28:29], v[16:17] op_sel:[0,0,0] op_sel_hi:[0,1,1]
    v_pk_fma_f32 v[48:49], v[48:49], v[36:37], v[18:19] op_sel:[0,0,0] op_sel_hi:[0,1,1]
    v_pk_mul_f32 v[20:21], v[50:51], v[36:37] op_sel:[1,1] op_sel_hi:[1,0] neg_lo:[1,0]
    v_pk_mul_f32 v[22:23], v[52:53], v[36:37] op_sel:[1,1] op_sel_hi:[1,0] neg_lo:[1,0]
    v_pk_fma_f32 v[50:51], v[50:51], v[36:37], v[20:21] op_sel:[0,0,0] op_sel_hi:[0,1,1]
    v_pk_fma_f32 v[52:53], v[52:53], v[36:37], v[22:23] op_sel:[0,0,0] op_sel_hi:[0,1,1]
    v_cvt_pk_bf16_f32 v106, v30, v60
    v_cvt_pk_bf16_f32 v110, -v31, -v61
    v_cvt_pk_bf16_f32 v107, v68, 0
    v_cvt_pk_bf16_f32 v111, -v69, 0
    v_cvt_pk_bf16_f32 v136, v38, v40
    v_cvt_pk_bf16_f32 v140, v39, v41
    v_cvt_pk_bf16_f32 v137, v42, v44
    v_cvt_pk_bf16_f32 v141, v43, v45
    v_cvt_pk_bf16_f32 v138, v46, v48
    v_cvt_pk_bf16_f32 v142, v47, v49
    v_cvt_pk_bf16_f32 v139, v50, v52
    v_cvt_pk_bf16_f32 v143, v51, v53
    v_pk_mul_f32 v[16:17], v[30:31], v[28:29] op_sel:[1,1] op_sel_hi:[1,0] neg_lo:[1,0]
    v_pk_mul_f32 v[18:19], v[68:69], v[28:29] op_sel:[1,1] op_sel_hi:[1,0] neg_lo:[1,0]
    v_pk_mul_f32 v[20:21], v[38:39], v[36:37] op_sel:[1,1] op_sel_hi:[1,0] neg_lo:[1,0]
    v_pk_mul_f32 v[22:23], v[40:41], v[36:37] op_sel:[1,1] op_sel_hi:[1,0] neg_lo:[1,0]
    v_pk_fma_f32 v[30:31], v[30:31], v[28:29], v[16:17] op_sel:[0,0,0] op_sel_hi:[0,1,1]
    v_pk_fma_f32 v[68:69], v[68:69], v[28:29], v[18:19] op_sel:[0,0,0] op_sel_hi:[0,1,1]
    v_pk_fma_f32 v[38:39], v[38:39], v[36:37], v[20:21] op_sel:[0,0,0] op_sel_hi:[0,1,1]
    v_pk_fma_f32 v[40:41], v[40:41], v[36:37], v[22:23] op_sel:[0,0,0] op_sel_hi:[0,1,1]
    v_cvt_pk_bf16_f32 v112, v30, v68
    v_cvt_pk_bf16_f32 v116, -v31, -v69
    v_pk_mul_f32 v[16:17], v[30:31], v[28:29] op_sel:[1,1] op_sel_hi:[1,0] neg_lo:[1,0]
    v_pk_mul_f32 v[18:19], v[68:69], v[28:29] op_sel:[1,1] op_sel_hi:[1,0] neg_lo:[1,0]
    v_pk_mul_f32 v[20:21], v[42:43], v[36:37] op_sel:[1,1] op_sel_hi:[1,0] neg_lo:[1,0]
    v_pk_mul_f32 v[22:23], v[44:45], v[36:37] op_sel:[1,1] op_sel_hi:[1,0] neg_lo:[1,0]
    v_pk_fma_f32 v[30:31], v[30:31], v[28:29], v[16:17] op_sel:[0,0,0] op_sel_hi:[0,1,1]
    v_pk_fma_f32 v[68:69], v[68:69], v[28:29], v[18:19] op_sel:[0,0,0] op_sel_hi:[0,1,1]
    v_pk_fma_f32 v[42:43], v[42:43], v[36:37], v[20:21] op_sel:[0,0,0] op_sel_hi:[0,1,1]
    v_pk_fma_f32 v[44:45], v[44:45], v[36:37], v[22:23] op_sel:[0,0,0] op_sel_hi:[0,1,1]
    v_cvt_pk_bf16_f32 v113, v30, v68
    v_cvt_pk_bf16_f32 v117, -v31, -v69
    v_pk_mul_f32 v[16:17], v[30:31], v[28:29] op_sel:[1,1] op_sel_hi:[1,0] neg_lo:[1,0]
    v_pk_mul_f32 v[18:19], v[68:69], v[28:29] op_sel:[1,1] op_sel_hi:[1,0] neg_lo:[1,0]
    v_pk_mul_f32 v[20:21], v[46:47], v[36:37] op_sel:[1,1] op_sel_hi:[1,0] neg_lo:[1,0]
    v_pk_mul_f32 v[22:23], v[48:49], v[36:37] op_sel:[1,1] op_sel_hi:[1,0] neg_lo:[1,0]
    v_pk_fma_f32 v[30:31], v[30:31], v[28:29], v[16:17] op_sel:[0,0,0] op_sel_hi:[0,1,1]
    v_pk_fma_f32 v[68:69], v[68:69], v[28:29], v[18:19] op_sel:[0,0,0] op_sel_hi:[0,1,1]
    v_pk_fma_f32 v[46:47], v[46:47], v[36:37], v[20:21] op_sel:[0,0,0] op_sel_hi:[0,1,1]
    v_pk_fma_f32 v[48:49], v[48:49], v[36:37], v[22:23] op_sel:[0,0,0] op_sel_hi:[0,1,1]
    v_cvt_pk_bf16_f32 v114, v30, v68
    v_cvt_pk_bf16_f32 v118, -v31, -v69
    v_pk_mul_f32 v[16:17], v[30:31], v[28:29] op_sel:[1,1] op_sel_hi:[1,0] neg_lo:[1,0]
    v_pk_mul_f32 v[18:19], v[68:69], v[28:29] op_sel:[1,1] op_sel_hi:[1,0] neg_lo:[1,0]
    v_pk_mul_f32 v[20:21], v[50:51], v[36:37] op_sel:[1,1] op_sel_hi:[1,0] neg_lo:[1,0]
    v_pk_mul_f32 v[22:23], v[52:53], v[36:37] op_sel:[1,1] op_sel_hi:[1,0] neg_lo:[1,0]
    v_pk_fma_f32 v[30:31], v[30:31], v[28:29], v[16:17] op_sel:[0,0,0] op_sel_hi:[0,1,1]
    v_pk_fma_f32 v[68:69], v[68:69], v[28:29], v[18:19] op_sel:[0,0,0] op_sel_hi:[0,1,1]
    v_pk_fma_f32 v[50:51], v[50:51], v[36:37], v[20:21] op_sel:[0,0,0] op_sel_hi:[0,1,1]
    v_pk_fma_f32 v[52:53], v[52:53], v[36:37], v[22:23] op_sel:[0,0,0] op_sel_hi:[0,1,1]
    v_cvt_pk_bf16_f32 v115, v30, v68
    v_cvt_pk_bf16_f32 v119, -v31, -v69
    v_cvt_pk_bf16_f32 v144, v38, v40
    v_cvt_pk_bf16_f32 v148, v39, v41
    v_cvt_pk_bf16_f32 v145, v42, v44
    v_cvt_pk_bf16_f32 v149, v43, v45
    v_cvt_pk_bf16_f32 v146, v46, v48
    v_cvt_pk_bf16_f32 v150, v47, v49
    v_cvt_pk_bf16_f32 v147, v50, v52
    v_cvt_pk_bf16_f32 v151, v51, v53
    s_cmp_lg_u32 s51, 2
    s_cbranch_scc1 S_NOUT
    s_mov_b32 s64, s16
    s_and_b32 s65, s17, 0xffff
    s_mov_b32 s66, 2359296
    s_mov_b32 s67, 0x00020000
    v_lshrrev_b32 v5, 3, v1
    v_and_b32 v4, 7, v1
    v_mul_u32_u24 v164, 9216, v4
    v_lshl_add_u32 v164, v5, 4, v164
    v_mul_u32_u24 v165, 33792, v5
    v_lshl_add_u32 v165, v4, 4, v165
    s_sub_u32 s84, s78, 2
    s_mul_i32 s85, s77, 73728
    s_mul_i32 s81, s84, 192
    s_add_u32 s85, s85, s81
    s_mov_b32 s99, 0x80000
W_70:
    ds_read_b32 v4, v2 offset:120
    s_waitcnt lgkmcnt(0)
    v_readfirstlane_b32 s80, v4
    s_cmp_ge_u32 s80, 3
    s_cbranch_scc1 WD_71
    s_sleep 2
    s_sub_u32 s99, s99, 1
    s_cmp_lg_u32 s99, 0
    s_cbranch_scc1 W_70
WD_71:
    s_mov_b32 exec_hi, 0xffff
    buffer_load_dwordx4 v[16:19], v164, s[64:67], s85 offen
    buffer_load_dwordx4 v[48:51], v164, s[64:67], s85 offen offset:96
    s_add_u32 s85, s85, 1152
    buffer_load_dwordx4 v[20:23], v164, s[64:67], s85 offen
    buffer_load_dwordx4 v[52:55], v164, s[64:67], s85 offen offset:96
    s_add_u32 s85, s85, 1152
    buffer_load_dwordx4 v[24:27], v164, s[64:67], s85 offen
    buffer_load_dwordx4 v[56:59], v164, s[64:67], s85 offen offset:96
    s_add_u32 s85, s85, 1152
    buffer_load_dwordx4 v[28:31], v164, s[64:67], s85 offen
    buffer_load_dwordx4 v[60:63], v164, s[64:67], s85 offen offset:96
    s_add_u32 s85, s85, 1152
    buffer_load_dwordx4 v[32:35], v164, s[64:67], s85 offen
    buffer_load_dwordx4 v[64:67], v164, s[64:67], s85 offen offset:96
    s_add_u32 s85, s85, 1152
    buffer_load_dwordx4 v[36:39], v164, s[64:67], s85 offen
    buffer_load_dwordx4 v[68:71], v164, s[64:67], s85 offen offset:96
    s_add_u32 s85, s85, 1152
    buffer_load_dwordx4 v[40:43], v164, s[64:67], s85 offen
    buffer_load_dwordx4 v[72:75], v164, s[64:67], s85 offen offset:96
    s_add_u32 s85, s85, 1152
    buffer_load_dwordx4 v[44:47], v164, s[64:67], s85 offen
    buffer_load_dwordx4 v[76:79], v164, s[64:67], s85 offen offset:96
    s_mul_i32 s81, s84, 405504
    s_add_u32 s81, s81, 0
    s_lshl_b32 s82, s77, 7
    s_add_u32 s82, s82, s81
    s_add_u32 s82, s82, 128
    s_waitcnt vmcnt(0)
    v_perm_b32 v80, v20, v16, s94
    v_perm_b32 v81, v28, v24, s94
    v_perm_b32 v82, v36, v32, s94
    v_perm_b32 v83, v44, v40, s94
    buffer_store_dwordx4 v[80:83], v165, s[68:71], s82 offen sc1
    s_add_u32 s82, s82, 4224
    v_perm_b32 v84, v20, v16, s95
    v_perm_b32 v85, v28, v24, s95
    v_perm_b32 v86, v36, v32, s95
    v_perm_b32 v87, v44, v40, s95
    buffer_store_dwordx4 v[84:87], v165, s[68:71], s82 offen sc1
    s_add_u32 s82, s82, 4224
    v_perm_b32 v152, v21, v17, s94
    v_perm_b32 v153, v29, v25, s94
    v_perm_b32 v154, v37, v33, s94
    v_perm_b32 v155, v45, v41, s94
    buffer_store_dwordx4 v[152:155], v165, s[68:71], s82 offen sc1
    s_add_u32 s82, s82, 4224
    v_perm_b32 v156, v21, v17, s95
    v_perm_b32 v157, v29, v25, s95
    v_perm_b32 v158, v37, v33, s95
    v_perm_b32 v159, v45, v41, s95
    buffer_store_dwordx4 v[156:159], v165, s[68:71], s82 offen sc1
    s_add_u32 s82, s82, 4224
    v_perm_b32 v80, v22, v18, s94
    v_perm_b32 v81, v30, v26, s94
    v_perm_b32 v82, v38, v34, s94
    v_perm_b32 v83, v46, v42, s94
    buffer_store_dwordx4 v[80:83], v165, s[68:71], s82 offen sc1
    s_add_u32 s82, s82, 4224
    v_perm_b32 v84, v22, v18, s95
    v_perm_b32 v85, v30, v26, s95
    v_perm_b32 v86, v38, v34, s95
    v_perm_b32 v87, v46, v42, s95
    buffer_store_dwordx4 v[84:87], v165, s[68:71], s82 offen sc1
    s_add_u32 s82, s82, 4224
    v_perm_b32 v152, v23, v19, s94
    v_perm_b32 v153, v31, v27, s94
    v_perm_b32 v154, v39, v35, s94
    v_perm_b32 v155, v47, v43, s94
    buffer_store_dwordx4 v[152:155], v165, s[68:71], s82 offen sc1
    s_add_u32 s82, s82, 4224
    v_perm_b32 v156, v23, v19, s95
    v_perm_b32 v157, v31, v27, s95
    v_perm_b32 v158, v39, v35, s95
    v_perm_b32 v159, v47, v43, s95
    buffer_store_dwordx4 v[156:159], v165, s[68:71], s82 offen sc1
    s_add_u32 s82, s82, 173184
    v_perm_b32 v80, v52, v48, s94
    v_perm_b32 v81, v60, v56, s94
    v_perm_b32 v82, v68, v64, s94
    v_perm_b32 v83, v76, v72, s94
    buffer_store_dwordx4 v[80:83], v165, s[68:71], s82 offen sc1
    s_add_u32 s82, s82, 4224
    v_perm_b32 v84, v52, v48, s95
    v_perm_b32 v85, v60, v56, s95
    v_perm_b32 v86, v68, v64, s95
    v_perm_b32 v87, v76, v72, s95
    buffer_store_dwordx4 v[84:87], v165, s[68:71], s82 offen sc1
    s_add_u32 s82, s82, 4224
    v_perm_b32 v152, v53, v49, s94
    v_perm_b32 v153, v61, v57, s94
    v_perm_b32 v154, v69, v65, s94
    v_perm_b32 v155, v77, v73, s94
    buffer_store_dwordx4 v[152:155], v165, s[68:71], s82 offen sc1
    s_add_u32 s82, s82, 4224
    v_perm_b32 v156, v53, v49, s95
    v_perm_b32 v157, v61, v57, s95
    v_perm_b32 v158, v69, v65, s95
    v_perm_b32 v159, v77, v73, s95
    buffer_store_dwordx4 v[156:159], v165, s[68:71], s82 offen sc1
    s_add_u32 s82, s82, 4224
    v_perm_b32 v80, v54, v50, s94
    v_perm_b32 v81, v62, v58, s94
    v_perm_b32 v82, v70, v66, s94
    v_perm_b32 v83, v78, v74, s94
    buffer_store_dwordx4 v[80:83], v165, s[68:71], s82 offen sc1
    s_add_u32 s82, s82, 4224
    v_perm_b32 v84, v54, v50, s95
    v_perm_b32 v85, v62, v58, s95
    v_perm_b32 v86, v70, v66, s95
    v_perm_b32 v87, v78, v74, s95
    buffer_store_dwordx4 v[84:87], v165, s[68:71], s82 offen sc1
    s_add_u32 s82, s82, 4224
    v_perm_b32 v152, v55, v51, s94
    v_perm_b32 v153, v63, v59, s94
    v_perm_b32 v154, v71, v67, s94
    v_perm_b32 v155, v79, v75, s94
    buffer_store_dwordx4 v[152:155], v165, s[68:71], s82 offen sc1
    s_add_u32 s82, s82, 4224
    v_perm_b32 v156, v55, v51, s95
    v_perm_b32 v157, v63, v59, s95
    v_perm_b32 v158, v71, v67, s95
    v_perm_b32 v159, v79, v75, s95
    buffer_store_dwordx4 v[156:159], v165, s[68:71], s82 offen sc1
    s_add_u32 s82, s82, 173184
    s_cmp_lg_u32 s77, 0
    s_cbranch_scc1 S_UT2
    v_mov_b32 v16, 0
    v_mov_b32 v17, 0
    v_mov_b32 v18, 0
    v_mov_b32 v19, 0
    s_add_u32 s82, s81, 33792
UZ_72:
    s_add_u32 s83, s81, 202752
    buffer_store_dwordx4 v[16:19], v165, s[68:71], s81 offen sc1
    buffer_store_dwordx4 v[16:19], v165, s[68:71], s83 offen sc1
    s_add_u32 s81, s81, 4224
    s_cmp_lt_u32 s81, s82
    s_cbranch_scc1 UZ_72
S_UT2:
    s_mov_b64 exec, -1
    s_waitcnt vmcnt(0)
    s_mov_b64 exec, 1
    ds_add_u32 v2, v3 offset:20
    s_mov_b64 exec, -1
S_NOUT:
    v_and_b32 v4, 7, v1
    v_lshlrev_b32 v5, 7, v1
    v_add_u32 v5, s91, v5
    v_xor_b32 v6, 0, v4
    v_lshl_add_u32 v152, v6, 4, v5
    v_xor_b32 v6, 1, v4
    v_lshl_add_u32 v153, v6, 4, v5
    v_xor_b32 v6, 2, v4
    v_lshl_add_u32 v154, v6, 4, v5
    v_xor_b32 v6, 3, v4
    v_lshl_add_u32 v155, v6, 4, v5
    v_xor_b32 v6, 4, v4
    v_lshl_add_u32 v156, v6, 4, v5
    v_xor_b32 v6, 5, v4
    v_lshl_add_u32 v157, v6, 4, v5
    v_xor_b32 v6, 6, v4
    v_lshl_add_u32 v158, v6, 4, v5
    v_xor_b32 v6, 7, v4
    v_lshl_add_u32 v159, v6, 4, v5
    v_lshrrev_b32 v4, 5, v1
    v_lshlrev_b32 v4, 2, v4
    v_bfe_u32 v5, v1, 3, 1
    v_add_u32 v4, v4, v5
    v_bfe_u32 v5, v1, 2, 1
    v_lshlrev_b32 v5, 2, v5
    v_bfe_u32 v6, v1, 4, 1
    v_lshl_add_u32 v5, v6, 1, v5
    v_bfe_u32 v6, v1, 1, 1
    v_add_u32 v5, v5, v6
    v_and_b32 v6, 1, v1
    v_lshlrev_b32 v6, 3, v6
    v_add_u32 v6, s91, v6
    v_xor_b32 v7, v4, v5
    v_lshl_add_u32 v160, v7, 4, v6
    v_lshl_add_u32 v160, v4, 7, v160
    v_add_u32 v4, 2, v4
    v_xor_b32 v7, v4, v5
    v_lshl_add_u32 v161, v7, 4, v6
    v_lshl_add_u32 v161, v4, 7, v161
    s_mov_b32 s99, 0x80000
W_73:
    ds_read_b32 v4, v2 offset:12
    s_waitcnt lgkmcnt(0)
    v_readfirstlane_b32 s80, v4
    s_cmp_ge_u32 s80, 8
    s_cbranch_scc1 WD_74
    s_sleep 4
    s_sub_u32 s99, s99, 1
    s_cmp_lg_u32 s99, 0
    s_cbranch_scc1 W_73
WD_74:
    ds_write_b128 v152, v[88:91] offset:0
    ds_write_b128 v156, v[92:95] offset:0
    ds_write_b128 v153, v[96:99] offset:0
    ds_write_b128 v157, v[100:103] offset:0
    ds_write_b128 v154, v[104:107] offset:0
    ds_write_b128 v158, v[108:111] offset:0
    ds_write_b128 v155, v[112:115] offset:0
    ds_write_b128 v159, v[116:119] offset:0
    ds_write_b128 v152, v[120:123] offset:8192
    ds_write_b128 v156, v[124:127] offset:8192
    ds_write_b128 v153, v[128:131] offset:8192
    ds_write_b128 v157, v[132:135] offset:8192
    ds_write_b128 v154, v[136:139] offset:8192
    ds_write_b128 v158, v[140:143] offset:8192
    ds_write_b128 v155, v[144:147] offset:8192
    ds_write_b128 v159, v[148:151] offset:8192
    ds_read_b64_tr_b16 v[16:17], v160 offset:0
    ds_read_b64_tr_b16 v[18:19], v161 offset:0
    ds_read_b64_tr_b16 v[20:21], v160 offset:8192
    ds_read_b64_tr_b16 v[22:23], v161 offset:8192
    ds_read_b64_tr_b16 v[24:25], v160 offset:1024
    ds_read_b64_tr_b16 v[26:27], v161 offset:1024
    ds_read_b64_tr_b16 v[28:29], v160 offset:9216
    ds_read_b64_tr_b16 v[30:31], v161 offset:9216
    ds_read_b64_tr_b16 v[32:33], v160 offset:2048
    ds_read_b64_tr_b16 v[34:35], v161 offset:2048
    ds_read_b64_tr_b16 v[36:37], v160 offset:10240
    ds_read_b64_tr_b16 v[38:39], v161 offset:10240
    s_waitcnt lgkmcnt(8)
    v_mfma_f32_32x32x16_bf16 v[72:87], v[16:19], v[20:23], 0
    ds_read_b64_tr_b16 v[40:41], v160 offset:3072
    ds_read_b64_tr_b16 v[42:43], v161 offset:3072
    ds_read_b64_tr_b16 v[44:45], v160 offset:11264
    ds_read_b64_tr_b16 v[46:47], v161 offset:11264
    s_waitcnt lgkmcnt(8)
    v_mfma_f32_32x32x16_bf16 v[72:87], v[24:27], v[28:31], v[72:87]
    ds_read_b64_tr_b16 v[48:49], v160 offset:4096
    ds_read_b64_tr_b16 v[50:51], v161 offset:4096
    ds_read_b64_tr_b16 v[52:53], v160 offset:12288
    ds_read_b64_tr_b16 v[54:55], v161 offset:12288
    s_waitcnt lgkmcnt(8)
    v_mfma_f32_32x32x16_bf16 v[72:87], v[32:35], v[36:39], v[72:87]
    ds_read_b64_tr_b16 v[56:57], v160 offset:5120
    ds_read_b64_tr_b16 v[58:59], v161 offset:5120
    ds_read_b64_tr_b16 v[60:61], v160 offset:13312
    ds_read_b64_tr_b16 v[62:63], v161 offset:13312
    s_waitcnt lgkmcnt(8)
    v_mfma_f32_32x32x16_bf16 v[72:87], v[40:43], v[44:47], v[72:87]
    ds_read_b64_tr_b16 v[64:65], v160 offset:6144
    ds_read_b64_tr_b16 v[66:67], v161 offset:6144
    ds_read_b64_tr_b16 v[68:69], v160 offset:14336
    ds_read_b64_tr_b16 v[70:71], v161 offset:14336
    s_waitcnt lgkmcnt(8)
    v_mfma_f32_32x32x16_bf16 v[72:87], v[48:51], v[52:55], v[72:87]
    ds_read_b64_tr_b16 v[16:17], v160 offset:7168
    ds_read_b64_tr_b16 v[18:19], v161 offset:7168
    ds_read_b64_tr_b16 v[20:21], v160 offset:15360
    ds_read_b64_tr_b16 v[22:23], v161 offset:15360
    s_waitcnt lgkmcnt(8)
    v_mfma_f32_32x32x16_bf16 v[72:87], v[56:59], v[60:63], v[72:87]
    s_waitcnt lgkmcnt(4)
    v_mfma_f32_32x32x16_bf16 v[72:87], v[64:67], v[68:71], v[72:87]
    s_waitcnt lgkmcnt(0)
    v_mfma_f32_32x32x16_bf16 v[72:87], v[16:19], v[20:23], v[72:87]
    v_and_b32 v54, 0xffff0000, v8
    v_and_b32 v55, 0xffff0000, v9
    v_and_b32 v56, 0xffff0000, v10
    v_and_b32 v57, 0xffff0000, v11
    v_and_b32 v58, 0xffff0000, v12
    v_and_b32 v59, 0xffff0000, v13
    v_mul_f32 v60, v54, v14
    v_mul_f32 v61, v55, v14
    v_mul_f32 v60, 0x3fb8aa3b, v60
    v_mul_f32 v61, 0.15915494, v61
    v_mul_f32 v62, v59, v57
    v_mul_f32 v63, v59, v56
    v_fma_f32 v30, v58, v56, -v62
    v_fma_f32 v31, v58, v57, v63
    v_mul_f32 v30, v30, v14
    v_mul_f32 v31, v31, v14
    v_mul_f32 v62, 0x3f800000, v60
    v_mul_f32 v63, 0x3f800000, v61
    v_mul_f32 v64, 0x41000000, v60
    v_mul_f32 v65, 0x41000000, v61
    v_mul_f32 v66, 0x43800000, v60
    v_mul_f32 v67, 0x43800000, v61
    v_exp_f32 v62, v62
    v_fract_f32 v63, v63
    v_exp_f32 v64, v64
    v_fract_f32 v65, v65
    v_exp_f32 v66, v66
    v_fract_f32 v67, v67
    v_cos_f32 v24, v63
    v_sin_f32 v25, v63
    v_cos_f32 v26, v65
    v_sin_f32 v27, v65
    v_cos_f32 v28, v67
    v_sin_f32 v29, v67
    s_nop 0
    v_mul_f32 v24, v24, v62
    v_mul_f32 v25, v25, v62
    v_mul_f32 v26, v26, v64
    v_mul_f32 v27, v27, v64
    v_mul_f32 v28, v28, v66
    v_mul_f32 v29, v29, v66
    v_mov_b32 v38, 1.0
    v_mov_b32 v39, 0
    v_mov_b32 v40, v26
    v_mov_b32 v41, v27
    v_pk_mul_f32 v[16:17], v[26:27], v[26:27] op_sel:[1,1] op_sel_hi:[1,0] neg_lo:[1,0]
    v_pk_mul_f32 v[18:19], v[24:25], v[24:25] op_sel:[1,1] op_sel_hi:[1,0] neg_lo:[1,0]
    v_pk_mul_f32 v[20:21], v[30:31], v[24:25] op_sel:[1,1] op_sel_hi:[1,0] neg_lo:[1,0]
    v_pk_mul_f32 v[22:23], v[30:31], v[26:27] op_sel:[1,1] op_sel_hi:[1,0] neg_lo:[1,0]
    v_pk_fma_f32 v[42:43], v[26:27], v[26:27], v[16:17] op_sel:[0,0,0] op_sel_hi:[0,1,1]
    v_pk_fma_f32 v[32:33], v[24:25], v[24:25], v[18:19] op_sel:[0,0,0] op_sel_hi:[0,1,1]
    v_pk_fma_f32 v[54:55], v[30:31], v[24:25], v[20:21] op_sel:[0,0,0] op_sel_hi:[0,1,1]
    v_pk_fma_f32 v[68:69], v[30:31], v[26:27], v[22:23] op_sel:[0,0,0] op_sel_hi:[0,1,1]
    v_pk_mul_f32 v[16:17], v[42:43], v[26:27] op_sel:[1,1] op_sel_hi:[1,0] neg_lo:[1,0]
    v_pk_mul_f32 v[18:19], v[42:43], v[42:43] op_sel:[1,1] op_sel_hi:[1,0] neg_lo:[1,0]
    v_pk_mul_f32 v[20:21], v[32:33], v[32:33] op_sel:[1,1] op_sel_hi:[1,0] neg_lo:[1,0]
    v_pk_mul_f32 v[22:23], v[30:31], v[32:33] op_sel:[1,1] op_sel_hi:[1,0] neg_lo:[1,0]
    v_pk_fma_f32 v[44:45], v[42:43], v[26:27], v[16:17] op_sel:[0,0,0] op_sel_hi:[0,1,1]
    v_pk_fma_f32 v[46:47], v[42:43], v[42:43], v[18:19] op_sel:[0,0,0] op_sel_hi:[0,1,1]
    v_pk_fma_f32 v[34:35], v[32:33], v[32:33], v[20:21] op_sel:[0,0,0] op_sel_hi:[0,1,1]
    v_pk_fma_f32 v[56:57], v[30:31], v[32:33], v[22:23] op_sel:[0,0,0] op_sel_hi:[0,1,1]
    v_pk_mul_f32 v[16:17], v[54:55], v[32:33] op_sel:[1,1] op_sel_hi:[1,0] neg_lo:[1,0]
    v_pk_fma_f32 v[58:59], v[54:55], v[32:33], v[16:17] op_sel:[0,0,0] op_sel_hi:[0,1,1]
    v_pk_mul_f32 v[18:19], v[46:47], v[26:27] op_sel:[1,1] op_sel_hi:[1,0] neg_lo:[1,0]
    v_pk_mul_f32 v[20:21], v[46:47], v[42:43] op_sel:[1,1] op_sel_hi:[1,0] neg_lo:[1,0]
    v_pk_mul_f32 v[22:23], v[46:47], v[44:45] op_sel:[1,1] op_sel_hi:[1,0] neg_lo:[1,0]
    v_pk_mul_f32 v[16:17], v[46:47], v[46:47] op_sel:[1,1] op_sel_hi:[1,0] neg_lo:[1,0]
    v_pk_fma_f32 v[48:49], v[46:47], v[26:27], v[18:19] op_sel:[0,0,0] op_sel_hi:[0,1,1]
    v_pk_fma_f32 v[50:51], v[46:47], v[42:43], v[20:21] op_sel:[0,0,0] op_sel_hi:[0,1,1]
    v_pk_fma_f32 v[52:53], v[46:47], v[44:45], v[22:23] op_sel:[0,0,0] op_sel_hi:[0,1,1]
    v_pk_fma_f32 v[36:37], v[46:47], v[46:47], v[16:17] op_sel:[0,0,0] op_sel_hi:[0,1,1]
    v_pk_mul_f32 v[18:19], v[30:31], v[34:35] op_sel:[1,1] op_sel_hi:[1,0] neg_lo:[1,0]
    v_pk_mul_f32 v[20:21], v[54:55], v[34:35] op_sel:[1,1] op_sel_hi:[1,0] neg_lo:[1,0]
    v_pk_mul_f32 v[22:23], v[56:57], v[34:35] op_sel:[1,1] op_sel_hi:[1,0] neg_lo:[1,0]
    v_pk_mul_f32 v[16:17], v[58:59], v[34:35] op_sel:[1,1] op_sel_hi:[1,0] neg_lo:[1,0]
    v_pk_fma_f32 v[60:61], v[30:31], v[34:35], v[18:19] op_sel:[0,0,0] op_sel_hi:[0,1,1]
    v_pk_fma_f32 v[62:63], v[54:55], v[34:35], v[20:21] op_sel:[0,0,0] op_sel_hi:[0,1,1]
    v_pk_fma_f32 v[64:65], v[56:57], v[34:35], v[22:23] op_sel:[0,0,0] op_sel_hi:[0,1,1]
    v_pk_fma_f32 v[66:67], v[58:59], v[34:35], v[16:17] op_sel:[0,0,0] op_sel_hi:[0,1,1]
    v_cvt_pk_bf16_f32 v128, v38, v40
    v_cvt_pk_bf16_f32 v132, v39, v41
    v_cvt_pk_bf16_f32 v129, v42, v44
    v_cvt_pk_bf16_f32 v133, v43, v45
    v_cvt_pk_bf16_f32 v130, v46, v48
    v_cvt_pk_bf16_f32 v134, v47, v49
    v_cvt_pk_bf16_f32 v131, v50, v52
    v_cvt_pk_bf16_f32 v135, v51, v53
    ds_write_b128 v152, v[128:131] offset:8192
    ds_write_b128 v156, v[132:135] offset:8192
    v_cvt_pk_bf16_f32 v120, v30, v54
    v_cvt_pk_bf16_f32 v124, -v31, -v55
    v_cvt_pk_bf16_f32 v121, v56, v58
    v_cvt_pk_bf16_f32 v125, -v57, -v59
    v_cvt_pk_bf16_f32 v122, v60, v62
    v_cvt_pk_bf16_f32 v126, -v61, -v63
    v_cvt_pk_bf16_f32 v123, v64, v66
    v_cvt_pk_bf16_f32 v127, -v65, -v67
    ds_write_b128 v152, v[120:123] offset:0
    ds_write_b128 v156, v[124:127] offset:0
    v_pk_mul_f32 v[18:19], v[30:31], v[28:29] op_sel:[1,1] op_sel_hi:[1,0] neg_lo:[1,0]
    v_pk_mul_f32 v[20:21], v[56:57], v[28:29] op_sel:[1,1] op_sel_hi:[1,0] neg_lo:[1,0]
    v_pk_mul_f32 v[22:23], v[60:61], v[28:29] op_sel:[1,1] op_sel_hi:[1,0] neg_lo:[1,0]
    v_pk_mul_f32 v[16:17], v[64:65], v[28:29] op_sel:[1,1] op_sel_hi:[1,0] neg_lo:[1,0]
    v_pk_fma_f32 v[30:31], v[30:31], v[28:29], v[18:19] op_sel:[0,0,0] op_sel_hi:[0,1,1]
    v_pk_fma_f32 v[56:57], v[56:57], v[28:29], v[20:21] op_sel:[0,0,0] op_sel_hi:[0,1,1]
    v_pk_fma_f32 v[60:61], v[60:61], v[28:29], v[22:23] op_sel:[0,0,0] op_sel_hi:[0,1,1]
    v_pk_fma_f32 v[64:65], v[64:65], v[28:29], v[16:17] op_sel:[0,0,0] op_sel_hi:[0,1,1]
    v_pk_mul_f32 v[18:19], v[68:69], v[28:29] op_sel:[1,1] op_sel_hi:[1,0] neg_lo:[1,0]
    v_pk_mul_f32 v[20:21], v[38:39], v[36:37] op_sel:[1,1] op_sel_hi:[1,0] neg_lo:[1,0]
    v_pk_mul_f32 v[22:23], v[40:41], v[36:37] op_sel:[1,1] op_sel_hi:[1,0] neg_lo:[1,0]
    v_pk_mul_f32 v[16:17], v[42:43], v[36:37] op_sel:[1,1] op_sel_hi:[1,0] neg_lo:[1,0]
    v_pk_fma_f32 v[68:69], v[68:69], v[28:29], v[18:19] op_sel:[0,0,0] op_sel_hi:[0,1,1]
    v_pk_fma_f32 v[38:39], v[38:39], v[36:37], v[20:21] op_sel:[0,0,0] op_sel_hi:[0,1,1]
    v_pk_fma_f32 v[40:41], v[40:41], v[36:37], v[22:23] op_sel:[0,0,0] op_sel_hi:[0,1,1]
    v_pk_fma_f32 v[42:43], v[42:43], v[36:37], v[16:17] op_sel:[0,0,0] op_sel_hi:[0,1,1]
    v_pk_mul_f32 v[18:19], v[44:45], v[36:37] op_sel:[1,1] op_sel_hi:[1,0] neg_lo:[1,0]
    v_pk_mul_f32 v[20:21], v[46:47], v[36:37] op_sel:[1,1] op_sel_hi:[1,0] neg_lo:[1,0]
    v_pk_mul_f32 v[22:23], v[48:49], v[36:37] op_sel:[1,1] op_sel_hi:[1,0] neg_lo:[1,0]
    v_pk_mul_f32 v[16:17], v[50:51], v[36:37] op_sel:[1,1] op_sel_hi:[1,0] neg_lo:[1,0]
    v_pk_fma_f32 v[44:45], v[44:45], v[36:37], v[18:19] op_sel:[0,0,0] op_sel_hi:[0,1,1]
    v_pk_fma_f32 v[46:47], v[46:47], v[36:37], v[20:21] op_sel:[0,0,0] op_sel_hi:[0,1,1]
    v_pk_fma_f32 v[48:49], v[48:49], v[36:37], v[22:23] op_sel:[0,0,0] op_sel_hi:[0,1,1]
    v_pk_fma_f32 v[50:51], v[50:51], v[36:37], v[16:17] op_sel:[0,0,0] op_sel_hi:[0,1,1]
    v_pk_mul_f32 v[18:19], v[52:53], v[36:37] op_sel:[1,1] op_sel_hi:[1,0] neg_lo:[1,0]
    v_pk_fma_f32 v[52:53], v[52:53], v[36:37], v[18:19] op_sel:[0,0,0] op_sel_hi:[0,1,1]
    v_cvt_pk_bf16_f32 v120, v30, v56
    v_cvt_pk_bf16_f32 v124, -v31, -v57
    v_cvt_pk_bf16_f32 v121, v60, 0
    v_cvt_pk_bf16_f32 v125, -v61, 0
    v_cvt_pk_bf16_f32 v122, v60, v64
    v_cvt_pk_bf16_f32 v126, -v61, -v65
    v_cvt_pk_bf16_f32 v123, v68, 0
    v_cvt_pk_bf16_f32 v127, -v69, 0
    ds_write_b128 v153, v[120:123] offset:0
    ds_write_b128 v157, v[124:127] offset:0
    v_cvt_pk_bf16_f32 v128, v38, v40
    v_cvt_pk_bf16_f32 v132, v39, v41
    v_cvt_pk_bf16_f32 v129, v42, v44
    v_cvt_pk_bf16_f32 v133, v43, v45
    v_cvt_pk_bf16_f32 v130, v46, v48
    v_cvt_pk_bf16_f32 v134, v47, v49
    v_cvt_pk_bf16_f32 v131, v50, v52
    v_cvt_pk_bf16_f32 v135, v51, v53
    ds_write_b128 v153, v[128:131] offset:8192
    ds_write_b128 v157, v[132:135] offset:8192
    v_pk_mul_f32 v[20:21], v[30:31], v[28:29] op_sel:[1,1] op_sel_hi:[1,0] neg_lo:[1,0]
    v_pk_mul_f32 v[22:23], v[60:61], v[28:29] op_sel:[1,1] op_sel_hi:[1,0] neg_lo:[1,0]
    v_pk_mul_f32 v[16:17], v[68:69], v[28:29] op_sel:[1,1] op_sel_hi:[1,0] neg_lo:[1,0]
    v_pk_mul_f32 v[18:19], v[38:39], v[36:37] op_sel:[1,1] op_sel_hi:[1,0] neg_lo:[1,0]
    v_pk_fma_f32 v[30:31], v[30:31], v[28:29], v[20:21] op_sel:[0,0,0] op_sel_hi:[0,1,1]
    v_pk_fma_f32 v[60:61], v[60:61], v[28:29], v[22:23] op_sel:[0,0,0] op_sel_hi:[0,1,1]
    v_pk_fma_f32 v[68:69], v[68:69], v[28:29], v[16:17] op_sel:[0,0,0] op_sel_hi:[0,1,1]
    v_pk_fma_f32 v[38:39], v[38:39], v[36:37], v[18:19] op_sel:[0,0,0] op_sel_hi:[0,1,1]
    v_pk_mul_f32 v[20:21], v[40:41], v[36:37] op_sel:[1,1] op_sel_hi:[1,0] neg_lo:[1,0]
    v_pk_mul_f32 v[22:23], v[42:43], v[36:37] op_sel:[1,1] op_sel_hi:[1,0] neg_lo:[1,0]
    v_pk_mul_f32 v[16:17], v[44:45], v[36:37] op_sel:[1,1] op_sel_hi:[1,0] neg_lo:[1,0]
    v_pk_mul_f32 v[18:19], v[46:47], v[36:37] op_sel:[1,1] op_sel_hi:[1,0] neg_lo:[1,0]
    v_pk_fma_f32 v[40:41], v[40:41], v[36:37], v[20:21] op_sel:[0,0,0] op_sel_hi:[0,1,1]
    v_pk_fma_f32 v[42:43], v[42:43], v[36:37], v[22:23] op_sel:[0,0,0] op_sel_hi:[0,1,1]
    v_pk_fma_f32 v[44:45], v[44:45], v[36:37], v[16:17] op_sel:[0,0,0] op_sel_hi:[0,1,1]
    v_pk_fma_f32 v[46:47], v[46:47], v[36:37], v[18:19] op_sel:[0,0,0] op_sel_hi:[0,1,1]
    v_cvt_pk_bf16_f32 v120, v30, v60
    v_cvt_pk_bf16_f32 v124, -v31, -v61
    v_cvt_pk_bf16_f32 v121, v68, 0
    v_cvt_pk_bf16_f32 v125, -v69, 0
    v_pk_mul_f32 v[20:21], v[30:31], v[28:29] op_sel:[1,1] op_sel_hi:[1,0] neg_lo:[1,0]
    v_pk_mul_f32 v[22:23], v[60:61], v[28:29] op_sel:[1,1] op_sel_hi:[1,0] neg_lo:[1,0]
    v_pk_mul_f32 v[16:17], v[68:69], v[28:29] op_sel:[1,1] op_sel_hi:[1,0] neg_lo:[1,0]
    v_pk_mul_f32 v[18:19], v[48:49], v[36:37] op_sel:[1,1] op_sel_hi:[1,0] neg_lo:[1,0]
    v_pk_fma_f32 v[30:31], v[30:31], v[28:29], v[20:21] op_sel:[0,0,0] op_sel_hi:[0,1,1]
    v_pk_fma_f32 v[60:61], v[60:61], v[28:29], v[22:23] op_sel:[0,0,0] op_sel_hi:[0,1,1]
    v_pk_fma_f32 v[68:69], v[68:69], v[28:29], v[16:17] op_sel:[0,0,0] op_sel_hi:[0,1,1]
    v_pk_fma_f32 v[48:49], v[48:49], v[36:37], v[18:19] op_sel:[0,0,0] op_sel_hi:[0,1,1]
    v_pk_mul_f32 v[20:21], v[50:51], v[36:37] op_sel:[1,1] op_sel_hi:[1,0] neg_lo:[1,0]
    v_pk_mul_f32 v[22:23], v[52:53], v[36:37] op_sel:[1,1] op_sel_hi:[1,0] neg_lo:[1,0]
    v_pk_fma_f32 v[50:51], v[50:51], v[36:37], v[20:21] op_sel:[0,0,0] op_sel_hi:[0,1,1]
    v_pk_fma_f32 v[52:53], v[52:53], v[36:37], v[22:23] op_sel:[0,0,0] op_sel_hi:[0,1,1]
    v_cvt_pk_bf16_f32 v122, v30, v60
    v_cvt_pk_bf16_f32 v126, -v31, -v61
    v_cvt_pk_bf16_f32 v123, v68, 0
    v_cvt_pk_bf16_f32 v127, -v69, 0
    ds_write_b128 v154, v[120:123] offset:0
    ds_write_b128 v158, v[124:127] offset:0
    v_cvt_pk_bf16_f32 v128, v38, v40
    v_cvt_pk_bf16_f32 v132, v39, v41
    v_cvt_pk_bf16_f32 v129, v42, v44
    v_cvt_pk_bf16_f32 v133, v43, v45
    v_cvt_pk_bf16_f32 v130, v46, v48
    v_cvt_pk_bf16_f32 v134, v47, v49
    v_cvt_pk_bf16_f32 v131, v50, v52
    v_cvt_pk_bf16_f32 v135, v51, v53
    ds_write_b128 v154, v[128:131] offset:8192
    ds_write_b128 v158, v[132:135] offset:8192
    v_pk_mul_f32 v[16:17], v[30:31], v[28:29] op_sel:[1,1] op_sel_hi:[1,0] neg_lo:[1,0]
    v_pk_mul_f32 v[18:19], v[68:69], v[28:29] op_sel:[1,1] op_sel_hi:[1,0] neg_lo:[1,0]
    v_pk_mul_f32 v[20:21], v[38:39], v[36:37] op_sel:[1,1] op_sel_hi:[1,0] neg_lo:[1,0]
    v_pk_mul_f32 v[22:23], v[40:41], v[36:37] op_sel:[1,1] op_sel_hi:[1,0] neg_lo:[1,0]
    v_pk_fma_f32 v[30:31], v[30:31], v[28:29], v[16:17] op_sel:[0,0,0] op_sel_hi:[0,1,1]
    v_pk_fma_f32 v[68:69], v[68:69], v[28:29], v[18:19] op_sel:[0,0,0] op_sel_hi:[0,1,1]
    v_pk_fma_f32 v[38:39], v[38:39], v[36:37], v[20:21] op_sel:[0,0,0] op_sel_hi:[0,1,1]
    v_pk_fma_f32 v[40:41], v[40:41], v[36:37], v[22:23] op_sel:[0,0,0] op_sel_hi:[0,1,1]
    v_cvt_pk_bf16_f32 v120, v30, v68
    v_cvt_pk_bf16_f32 v124, -v31, -v69
    v_pk_mul_f32 v[16:17], v[30:31], v[28:29] op_sel:[1,1] op_sel_hi:[1,0] neg_lo:[1,0]
    v_pk_mul_f32 v[18:19], v[68:69], v[28:29] op_sel:[1,1] op_sel_hi:[1,0] neg_lo:[1,0]
    v_pk_mul_f32 v[20:21], v[42:43], v[36:37] op_sel:[1,1] op_sel_hi:[1,0] neg_lo:[1,0]
    v_pk_mul_f32 v[22:23], v[44:45], v[36:37] op_sel:[1,1] op_sel_hi:[1,0] neg_lo:[1,0]
    v_pk_fma_f32 v[30:31], v[30:31], v[28:29], v[16:17] op_sel:[0,0,0] op_sel_hi:[0,1,1]
    v_pk_fma_f32 v[68:69], v[68:69], v[28:29], v[18:19] op_sel:[0,0,0] op_sel_hi:[0,1,1]
    v_pk_fma_f32 v[42:43], v[42:43], v[36:37], v[20:21] op_sel:[0,0,0] op_sel_hi:[0,1,1]
    v_pk_fma_f32 v[44:45], v[44:45], v[36:37], v[22:23] op_sel:[0,0,0] op_sel_hi:[0,1,1]
    v_cvt_pk_bf16_f32 v121, v30, v68
    v_cvt_pk_bf16_f32 v125, -v31, -v69
    v_pk_mul_f32 v[16:17], v[30:31], v[28:29] op_sel:[1,1] op_sel_hi:[1,0] neg_lo:[1,0]
    v_pk_mul_f32 v[18:19], v[68:69], v[28:29] op_sel:[1,1] op_sel_hi:[1,0] neg_lo:[1,0]
    v_pk_mul_f32 v[20:21], v[46:47], v[36:37] op_sel:[1,1] op_sel_hi:[1,0] neg_lo:[1,0]
    v_pk_mul_f32 v[22:23], v[48:49], v[36:37] op_sel:[1,1] op_sel_hi:[1,0] neg_lo:[1,0]
    v_pk_fma_f32 v[30:31], v[30:31], v[28:29], v[16:17] op_sel:[0,0,0] op_sel_hi:[0,1,1]
    v_pk_fma_f32 v[68:69], v[68:69], v[28:29], v[18:19] op_sel:[0,0,0] op_sel_hi:[0,1,1]
    v_pk_fma_f32 v[46:47], v[46:47], v[36:37], v[20:21] op_sel:[0,0,0] op_sel_hi:[0,1,1]
    v_pk_fma_f32 v[48:49], v[48:49], v[36:37], v[22:23] op_sel:[0,0,0] op_sel_hi:[0,1,1]
    v_cvt_pk_bf16_f32 v122, v30, v68
    v_cvt_pk_bf16_f32 v126, -v31, -v69
    v_pk_mul_f32 v[16:17], v[30:31], v[28:29] op_sel:[1,1] op_sel_hi:[1,0] neg_lo:[1,0]
    v_pk_mul_f32 v[18:19], v[68:69], v[28:29] op_sel:[1,1] op_sel_hi:[1,0] neg_lo:[1,0]
    v_pk_mul_f32 v[20:21], v[50:51], v[36:37] op_sel:[1,1] op_sel_hi:[1,0] neg_lo:[1,0]
    v_pk_mul_f32 v[22:23], v[52:53], v[36:37] op_sel:[1,1] op_sel_hi:[1,0] neg_lo:[1,0]
    v_pk_fma_f32 v[30:31], v[30:31], v[28:29], v[16:17] op_sel:[0,0,0] op_sel_hi:[0,1,1]
    v_pk_fma_f32 v[68:69], v[68:69], v[28:29], v[18:19] op_sel:[0,0,0] op_sel_hi:[0,1,1]
    v_pk_fma_f32 v[50:51], v[50:51], v[36:37], v[20:21] op_sel:[0,0,0] op_sel_hi:[0,1,1]
    v_pk_fma_f32 v[52:53], v[52:53], v[36:37], v[22:23] op_sel:[0,0,0] op_sel_hi:[0,1,1]
    v_cvt_pk_bf16_f32 v123, v30, v68
    v_cvt_pk_bf16_f32 v127, -v31, -v69
    ds_write_b128 v155, v[120:123] offset:0
    ds_write_b128 v159, v[124:127] offset:0
    v_cvt_pk_bf16_f32 v128, v38, v40
    v_cvt_pk_bf16_f32 v132, v39, v41
    v_cvt_pk_bf16_f32 v129, v42, v44
    v_cvt_pk_bf16_f32 v133, v43, v45
    v_cvt_pk_bf16_f32 v130, v46, v48
    v_cvt_pk_bf16_f32 v134, v47, v49
    v_cvt_pk_bf16_f32 v131, v50, v52
    v_cvt_pk_bf16_f32 v135, v51, v53
    ds_write_b128 v155, v[128:131] offset:8192
    ds_write_b128 v159, v[132:135] offset:8192
    ds_read_b64_tr_b16 v[16:17], v160 offset:0
    ds_read_b64_tr_b16 v[18:19], v161 offset:0
    ds_read_b64_tr_b16 v[20:21], v160 offset:8192
    ds_read_b64_tr_b16 v[22:23], v161 offset:8192
    ds_read_b64_tr_b16 v[24:25], v160 offset:1024
    ds_read_b64_tr_b16 v[26:27], v161 offset:1024
    ds_read_b64_tr_b16 v[28:29], v160 offset:9216
    ds_read_b64_tr_b16 v[30:31], v161 offset:9216
    ds_read_b64_tr_b16 v[32:33], v160 offset:2048
    ds_read_b64_tr_b16 v[34:35], v161 offset:2048
    ds_read_b64_tr_b16 v[36:37], v160 offset:10240
    ds_read_b64_tr_b16 v[38:39], v161 offset:10240
    s_waitcnt lgkmcnt(8)
    v_mfma_f32_32x32x16_bf16 v[72:87], v[16:19], v[20:23], v[72:87]
    ds_read_b64_tr_b16 v[40:41], v160 offset:3072
    ds_read_b64_tr_b16 v[42:43], v161 offset:3072
    ds_read_b64_tr_b16 v[44:45], v160 offset:11264
    ds_read_b64_tr_b16 v[46:47], v161 offset:11264
    s_waitcnt lgkmcnt(8)
    v_mfma_f32_32x32x16_bf16 v[72:87], v[24:27], v[28:31], v[72:87]
    ds_read_b64_tr_b16 v[48:49], v160 offset:4096
    ds_read_b64_tr_b16 v[50:51], v161 offset:4096
    ds_read_b64_tr_b16 v[52:53], v160 offset:12288
    ds_read_b64_tr_b16 v[54:55], v161 offset:12288
    s_waitcnt lgkmcnt(8)
    v_mfma_f32_32x32x16_bf16 v[72:87], v[32:35], v[36:39], v[72:87]
    ds_read_b64_tr_b16 v[56:57], v160 offset:5120
    ds_read_b64_tr_b16 v[58:59], v161 offset:5120
    ds_read_b64_tr_b16 v[60:61], v160 offset:13312
    ds_read_b64_tr_b16 v[62:63], v161 offset:13312
    s_waitcnt lgkmcnt(8)
    v_mfma_f32_32x32x16_bf16 v[72:87], v[40:43], v[44:47], v[72:87]
    ds_read_b64_tr_b16 v[64:65], v160 offset:6144
    ds_read_b64_tr_b16 v[66:67], v161 offset:6144
    ds_read_b64_tr_b16 v[68:69], v160 offset:14336
    ds_read_b64_tr_b16 v[70:71], v161 offset:14336
    s_waitcnt lgkmcnt(8)
    v_mfma_f32_32x32x16_bf16 v[72:87], v[48:51], v[52:55], v[72:87]
    ds_read_b64_tr_b16 v[16:17], v160 offset:7168
    ds_read_b64_tr_b16 v[18:19], v161 offset:7168
    ds_read_b64_tr_b16 v[20:21], v160 offset:15360
    ds_read_b64_tr_b16 v[22:23], v161 offset:15360
    s_waitcnt lgkmcnt(8)
    v_mfma_f32_32x32x16_bf16 v[72:87], v[56:59], v[60:63], v[72:87]
    s_waitcnt lgkmcnt(4)
    v_mfma_f32_32x32x16_bf16 v[72:87], v[64:67], v[68:71], v[72:87]
    s_waitcnt lgkmcnt(0)
    v_mfma_f32_32x32x16_bf16 v[72:87], v[16:19], v[20:23], v[72:87]
    v_mov_b32 v28, 0
    v_mov_b32 v29, 0
    v_mov_b32 v30, 0
    v_mov_b32 v31, 0
    v_lshlrev_b32 v6, 4, v1
    v_add_u32 v4, s91, v6
    s_mov_b64 exec, 0xffffffff
    ds_write_b128 v4, v[28:31] offset:4112
    ds_write_b128 v4, v[28:31] offset:8752
    s_mov_b64 exec, -1
    v_and_b32 v16, 31, v1
    v_lshrrev_b32 v17, 5, v1
    s_add_u32 s80, s91, 528
    v_lshlrev_b32 v4, 4, v16
    v_sub_u32 v18, s80, v4
    v_subrev_u32 v19, 8, v18
    v_cmp_eq_u32 vcc, 1, v17
    v_lshlrev_b32 v4, 3, v17
    v_sub_u32 v21, v18, v4
    v_add_u32 v21, 8, v21
    v_cndmask_b32 v20, v18, v19, vcc
    v_lshlrev_b32 v4, 9, v17
    v_sub_u32 v22, v18, v4
    v_sub_u32 v23, v19, v4
    v_sub_u32 v24, v22, v4
    v_sub_u32 v25, v23, v4
    v_and_b32 v4, 1, v16
    v_cmp_eq_u32 vcc, 1, v4
    v_add_f32 v72, v72, v15
    v_cvt_pk_bf16_f32 v32, v75, v74
    v_cvt_pk_bf16_f32 v33, v73, v72
    v_cvt_pk_bf16_f32 v34, v78, v77
    v_cvt_pk_bf16_f32 v35, v76, v76
    v_cvt_pk_bf16_f32 v36, v82, v82
    v_cvt_pk_bf16_f32 v37, v81, v81
    v_cvt_pk_bf16_f32 v38, v81, v80
    v_cvt_pk_bf16_f32 v39, v80, v80
    v_cndmask_b32 v4, v84, v85, vcc
    v_cndmask_b32 v5, v86, v87, vcc
    v_cvt_pk_bf16_f32 v40, v85, v85
    v_cvt_pk_bf16_f32 v41, v85, v4
    v_cvt_pk_bf16_f32 v42, v84, v84
    v_cvt_pk_bf16_f32 v43, v84, v84
    v_cvt_pk_bf16_f32 v44, v87, v87
    v_cvt_pk_bf16_f32 v45, v87, v5
    v_cvt_pk_bf16_f32 v46, v86, v86
    v_cvt_pk_bf16_f32 v47, v86, v86
    ds_write_b64 v20, v[32:33] offset:3584
    ds_write_b64 v21, v[32:33] offset:8224
    ds_write_b64 v20, v[34:35] offset:3072
    ds_write_b64 v21, v[34:35] offset:7712
    ds_write_b64 v23, v[36:37] offset:2560
    ds_write_b64 v22, v[38:39] offset:2560
    ds_write_b128 v22, v[36:39] offset:7200
    ds_write_b64 v25, v[40:41] offset:1536
    ds_write_b64 v24, v[42:43] offset:1536
    ds_write_b128 v24, v[40:43] offset:6176
    ds_write_b64 v25, v[44:45] offset:1024
    ds_write_b64 v24, v[46:47] offset:1024
    ds_write_b128 v24, v[44:47] offset:5664
    s_mov_b32 s99, 0x80000
W_77:
    ds_read_b32 v4, v2 offset:28
    s_waitcnt lgkmcnt(0)
    v_readfirstlane_b32 s80, v4
    s_cmp_ge_u32 s80, 1
    s_cbranch_scc1 WD_78
    s_sleep 4
    s_sub_u32 s99, s99, 1
    s_cmp_lg_u32 s99, 0
    s_cbranch_scc1 W_77
WD_78:
    s_mov_b32 s83, 0x40000
    s_mul_i32 s81, s90, 683
    s_lshr_b32 s81, s81, 16
    s_lshl_b32 s81, s81, 7
    s_add_u32 s81, s81, 8330240
    s_mov_b64 exec, 1
UL_75:
    buffer_load_dword v4, v2, s[68:71], s81 offen sc1
    s_waitcnt vmcnt(0)
    v_readfirstlane_b32 s80, v4
    s_cmp_eq_u32 s80, 1
    s_cbranch_scc1 UD_76
    s_sub_u32 s83, s83, 1
    s_cmp_eq_u32 s83, 0
    s_cbranch_scc1 UD_76
    s_sleep 4
    s_branch UL_75
UD_76:
    s_mov_b64 exec, -1
    s_mul_i32 s82, s90, 4224
    s_add_u32 s82, s82, 0
    v_lshlrev_b32 v4, 4, v1
    s_add_u32 s80, s82, 74
    s_mov_b32 s81, s92
    s_mov_b32 s82, 0
S_UDMA:
    s_add_u32 m0, s81, 0
    s_add_u32 s83, s80, 0
    buffer_load_dwordx4 v4, s[68:71], s83 offen sc1 lds
    s_add_u32 m0, s81, 1024
    s_add_u32 s83, s80, 1024
    buffer_load_dwordx4 v4, s[68:71], s83 offen sc1 lds
    s_add_u32 m0, s81, 2048
    s_add_u32 s83, s80, 2048
    buffer_load_dwordx4 v4, s[68:71], s83 offen sc1 lds
    s_add_u32 m0, s81, 3072
    s_add_u32 s83, s80, 3072
    buffer_load_dwordx4 v4, s[68:71], s83 offen sc1 lds
    s_add_u32 m0, s81, 4096
    s_add_u32 s83, s80, 4096
    s_mov_b64 exec, 0xff
    buffer_load_dwordx4 v4, s[68:71], s83 offen sc1 lds
    s_mov_b64 exec, -1
    s_add_u32 s80, s80, 2
    s_add_u32 s81, s81, 4288
    s_add_u32 s82, s82, 1
    s_cmp_lt_u32 s82, 4
    s_cbranch_scc1 S_UDMA
    v_and_b32 v4, 3, v1
    v_mul_u32_u24 v8, 4288, v4
    v_bfe_u32 v4, v1, 2, 2
    v_lshrrev_b32 v5, 4, v1
    v_add_u32 v4, v4, v5
    v_lshl_add_u32 v8, v4, 4, v8
    v_add_u32 v8, s92, v8
    v_and_b32 v4, 1, v1
    v_mul_u32_u24 v9, 4640, v4
    v_lshlrev_b32 v10, 3, v4
    v_lshl_add_u32 v9, v5, 4, v9
    v_lshl_add_u32 v10, v5, 4, v10
    v_bfe_u32 v4, v1, 1, 3
    v_lshlrev_b32 v4, 6, v4
    v_add_u32 v10, v10, v4
    v_sub_u32 v9, v9, v4
    s_add_u32 s80, s91, 480
    v_add_u32 v9, s80, v9
    v_mov_b32 v16, 0
    v_mov_b32 v17, 0
    v_mov_b32 v18, 0
    v_mov_b32 v19, 0
    v_mov_b32 v20, 0
    v_mov_b32 v21, 0
    v_mov_b32 v22, 0
    v_mov_b32 v23, 0
    v_mov_b32 v24, 0
    v_mov_b32 v25, 0
    v_mov_b32 v26, 0
    v_mov_b32 v27, 0
    v_mov_b32 v28, 0
    v_mov_b32 v29, 0
    v_mov_b32 v30, 0
    v_mov_b32 v31, 0
    v_mov_b32 v32, 0
    v_mov_b32 v33, 0
    v_mov_b32 v34, 0
    v_mov_b32 v35, 0
    v_mov_b32 v36, 0
    v_mov_b32 v37, 0
    v_mov_b32 v38, 0
    v_mov_b32 v39, 0
    v_mov_b32 v40, 0
    v_mov_b32 v41, 0
    v_mov_b32 v42, 0
    v_mov_b32 v43, 0
    v_mov_b32 v44, 0
    v_mov_b32 v45, 0
    v_mov_b32 v46, 0
    v_mov_b32 v47, 0
    s_mov_b32 s93, 0
    s_waitcnt vmcnt(0)
    s_setprio 3
S_CONV:
    ds_read_b128 v[48:51], v8 offset:0
    ds_read_b128 v[80:83], v9 offset:3584
    s_waitcnt lgkmcnt(0)
    v_mfma_f32_16x16x32_bf16 v[16:19], v[48:51], v[80:83], v[16:19]
    ds_read_b128 v[84:87], v9 offset:3072
    s_waitcnt lgkmcnt(0)
    v_mfma_f32_16x16x32_bf16 v[20:23], v[48:51], v[84:87], v[20:23]
    ds_read_b128 v[52:55], v8 offset:512
    s_waitcnt lgkmcnt(0)
    v_mfma_f32_16x16x32_bf16 v[24:27], v[52:55], v[84:87], v[24:27]
    v_mfma_f32_16x16x32_bf16 v[20:23], v[52:55], v[80:83], v[20:23]
    ds_read_b128 v[88:91], v9 offset:2560
    s_waitcnt lgkmcnt(0)
    v_mfma_f32_16x16x32_bf16 v[28:31], v[52:55], v[88:91], v[28:31]
    v_mfma_f32_16x16x32_bf16 v[24:27], v[48:51], v[88:91], v[24:27]
    ds_read_b128 v[56:59], v8 offset:1024
    s_waitcnt lgkmcnt(0)
    v_mfma_f32_16x16x32_bf16 v[32:35], v[56:59], v[88:91], v[32:35]
    v_mfma_f32_16x16x32_bf16 v[28:31], v[56:59], v[84:87], v[28:31]
    v_mfma_f32_16x16x32_bf16 v[24:27], v[56:59], v[80:83], v[24:27]
    ds_read_b128 v[92:95], v9 offset:2048
    s_waitcnt lgkmcnt(0)
    v_mfma_f32_16x16x32_bf16 v[36:39], v[56:59], v[92:95], v[36:39]
    v_mfma_f32_16x16x32_bf16 v[32:35], v[52:55], v[92:95], v[32:35]
    v_mfma_f32_16x16x32_bf16 v[28:31], v[48:51], v[92:95], v[28:31]
    ds_read_b128 v[60:63], v8 offset:1536
    s_waitcnt lgkmcnt(0)
    v_mfma_f32_16x16x32_bf16 v[40:43], v[60:63], v[92:95], v[40:43]
    v_mfma_f32_16x16x32_bf16 v[36:39], v[60:63], v[88:91], v[36:39]
    v_mfma_f32_16x16x32_bf16 v[32:35], v[60:63], v[84:87], v[32:35]
    ds_read_b128 v[96:99], v9 offset:1536
    s_waitcnt lgkmcnt(0)
    v_mfma_f32_16x16x32_bf16 v[44:47], v[60:63], v[96:99], v[44:47]
    v_mfma_f32_16x16x32_bf16 v[40:43], v[56:59], v[96:99], v[40:43]
    v_mfma_f32_16x16x32_bf16 v[36:39], v[52:55], v[96:99], v[36:39]
    ds_read_b128 v[64:67], v8 offset:2048
    s_waitcnt lgkmcnt(0)
    v_mfma_f32_16x16x32_bf16 v[44:47], v[64:67], v[92:95], v[44:47]
    v_mfma_f32_16x16x32_bf16 v[40:43], v[64:67], v[88:91], v[40:43]
    v_mfma_f32_16x16x32_bf16 v[36:39], v[64:67], v[84:87], v[36:39]
    ds_read_b128 v[100:103], v9 offset:1024
    s_waitcnt lgkmcnt(0)
    v_mfma_f32_16x16x32_bf16 v[44:47], v[56:59], v[100:103], v[44:47]
    v_mfma_f32_16x16x32_bf16 v[40:43], v[52:55], v[100:103], v[40:43]
    v_mfma_f32_16x16x32_bf16 v[36:39], v[48:51], v[100:103], v[36:39]
    ds_read_b128 v[68:71], v8 offset:2560
    s_waitcnt lgkmcnt(0)
    v_mfma_f32_16x16x32_bf16 v[44:47], v[68:71], v[88:91], v[44:47]
    v_mfma_f32_16x16x32_bf16 v[40:43], v[68:71], v[84:87], v[40:43]
    v_mfma_f32_16x16x32_bf16 v[36:39], v[68:71], v[80:83], v[36:39]
    ds_read_b128 v[104:107], v9 offset:512
    s_waitcnt lgkmcnt(0)
    v_mfma_f32_16x16x32_bf16 v[44:47], v[52:55], v[104:107], v[44:47]
    v_mfma_f32_16x16x32_bf16 v[40:43], v[48:51], v[104:107], v[40:43]
    v_mfma_f32_16x16x32_bf16 v[32:35], v[48:51], v[96:99], v[32:35]
    ds_read_b128 v[72:75], v8 offset:3072
    s_waitcnt lgkmcnt(0)
    v_mfma_f32_16x16x32_bf16 v[44:47], v[72:75], v[84:87], v[44:47]
    v_mfma_f32_16x16x32_bf16 v[40:43], v[72:75], v[80:83], v[40:43]
    v_mfma_f32_16x16x32_bf16 v[32:35], v[64:67], v[80:83], v[32:35]
    ds_read_b128 v[108:111], v9 offset:0
    s_waitcnt lgkmcnt(0)
    v_mfma_f32_16x16x32_bf16 v[44:47], v[48:51], v[108:111], v[44:47]
    v_mfma_f32_16x16x32_bf16 v[28:31], v[60:63], v[80:83], v[28:31]
    ds_read_b128 v[76:79], v8 offset:3584
    s_waitcnt lgkmcnt(0)
    v_mfma_f32_16x16x32_bf16 v[44:47], v[76:79], v[80:83], v[44:47]
    v_add_u32 v8, 64, v8
    v_add_u32 v9, 64, v9
    s_add_u32 s93, s93, 1
    s_cmp_lt_u32 s93, 8
    s_cbranch_scc1 S_CONV
    s_lshl_b32 s80, s90, 12
    s_add_u32 s80, s80, 5046272
    s_nop 7
    s_setprio 3
    v_add_u32 v10, s92, v10
    v_cvt_pk_bf16_f32 v48, v16, v17
    v_cvt_pk_bf16_f32 v49, v18, v19
    ds_write_b64 v10, v[48:49] offset:0
    v_cvt_pk_bf16_f32 v50, v20, v21
    v_cvt_pk_bf16_f32 v51, v22, v23
    ds_write_b64 v10, v[50:51] offset:512
    v_cvt_pk_bf16_f32 v52, v24, v25
    v_cvt_pk_bf16_f32 v53, v26, v27
    ds_write_b64 v10, v[52:53] offset:1024
    v_cvt_pk_bf16_f32 v54, v28, v29
    v_cvt_pk_bf16_f32 v55, v30, v31
    ds_write_b64 v10, v[54:55] offset:1536
    v_cvt_pk_bf16_f32 v56, v32, v33
    v_cvt_pk_bf16_f32 v57, v34, v35
    ds_write_b64 v10, v[56:57] offset:2048
    v_cvt_pk_bf16_f32 v58, v36, v37
    v_cvt_pk_bf16_f32 v59, v38, v39
    ds_write_b64 v10, v[58:59] offset:2560
    v_cvt_pk_bf16_f32 v60, v40, v41
    v_cvt_pk_bf16_f32 v61, v42, v43
    ds_write_b64 v10, v[60:61] offset:3072
    v_cvt_pk_bf16_f32 v62, v44, v45
    v_cvt_pk_bf16_f32 v63, v46, v47
    ds_write_b64 v10, v[62:63] offset:3584
    v_lshlrev_b32 v6, 4, v1
    v_add_u32 v4, s92, v6
    ds_read_b128 v[16:19], v4 offset:0
    ds_read_b128 v[20:23], v4 offset:1024
    ds_read_b128 v[24:27], v4 offset:2048
    ds_read_b128 v[28:31], v4 offset:3072
    s_waitcnt lgkmcnt(0)
    buffer_store_dwordx4 v[16:19], v6, s[68:71], s80 offen offset:0 sc1
    buffer_store_dwordx4 v[20:23], v6, s[68:71], s80 offen offset:1024 sc1
    buffer_store_dwordx4 v[24:27], v6, s[68:71], s80 offen offset:2048 sc1
    buffer_store_dwordx4 v[28:31], v6, s[68:71], s80 offen offset:3072 sc1
    s_mov_b64 exec, 1
    ds_add_u32 v2, v3 offset:136
    s_mov_b64 exec, -1
    s_mov_b32 s99, 0x80000
W_79:
    ds_read_b32 v4, v2 offset:28
    s_waitcnt lgkmcnt(0)
    v_readfirstlane_b32 s80, v4
    s_cmp_ge_u32 s80, 1
    s_cbranch_scc1 WD_80
    s_sleep 4
    s_sub_u32 s99, s99, 1
    s_cmp_lg_u32 s99, 0
    s_cbranch_scc1 W_79
WD_80:
    s_mul_i32 s81, s90, 911
    s_lshr_b32 s81, s81, 16
    s_lshl_b32 s81, s81, 7
    s_add_u32 s81, s81, 8327168
    s_waitcnt vmcnt(0)
    s_mov_b64 exec, 1
    v_mov_b32 v4, 1
    buffer_atomic_add v4, v2, s[68:71], s81 offen sc0
    s_waitcnt vmcnt(0)
    v_readfirstlane_b32 s80, v4
    s_cmp_lg_u32 s80, 71
    s_cbranch_scc1 S_YX
    buffer_store_dword v3, v2, s[68:71], s81 offen offset:1024 sc1
S_YX:
    s_mov_b64 exec, -1
    s_cmp_ge_u32 s51, 2
    s_cbranch_scc1 S_TAIL
S_WO:
    s_mov_b32 s52, s42
    s_and_b32 s53, s43, 0xffff
    s_mov_b32 s54, 663552
    s_mov_b32 s55, 0x00020000
    s_mov_b32 s56, s44
    s_and_b32 s57, s45, 0xffff
    s_mov_b32 s58, 4718592
    s_mov_b32 s59, 0x00020000
    s_mov_b32 s99, 0x80000
W_81:
    ds_read_b32 v4, v2 offset:136
    s_waitcnt lgkmcnt(0)
    v_readfirstlane_b32 s80, v4
    s_cmp_ge_u32 s80, s79
    s_cbranch_scc1 WD_82
    s_sleep 4
    s_sub_u32 s99, s99, 1
    s_cmp_lg_u32 s99, 0
    s_cbranch_scc1 W_81
WD_82:
    s_mov_b32 s93, s51
S_WOL:
    s_lshl_b32 s80, s93, 6
    v_add_u32 v4, s80, v1
    v_mul_u32_u24 v8, 7282, v4
    v_lshrrev_b32 v8, 16, v8
    v_mul_u32_u24 v9, 9, v8
    v_sub_u32 v9, v4, v9
    v_and_b32 v10, 3, v8
    v_bfe_u32 v4, v8, 2, 2
    v_lshl_add_u32 v10, v10, 2, v4
    v_lshrrev_b32 v11, 4, v8
    v_mul_u32_u24 v12, 18, v11
    v_add_u32 v12, v12, v10
    v_mul_u32_u24 v12, 1152, v12
    v_lshl_add_u32 v12, v9, 4, v12
    v_lshrrev_b32 v4, 1, v10
    v_lshl_add_u32 v4, v11, 3, v4
    v_mul_u32_u24 v13, 18, v4
    v_and_b32 v4, 1, v10
    v_add3_u32 v13, v13, v4, 16
    v_mul_u32_u24 v13, 1152, v13
    v_lshl_add_u32 v13, v9, 4, v13
    s_mul_i32 s80, s78, 144
    s_lshl_b32 s81, s93, 10
    s_add_u32 s81, s81, 80896
    s_add_u32 m0, s81, 73728
    s_mov_b32 s82, 8
    buffer_load_dwordx4 v13, s[52:55], s80 offen lds
S_WOP:
    s_mov_b32 m0, s81
    s_add_u32 s81, s81, 9216
    buffer_load_dwordx4 v12, s[52:55], s80 offen lds
    s_add_u32 s80, s80, 82944
    s_sub_u32 s82, s82, 1
    s_cmp_lg_u32 s82, 0
    s_cbranch_scc1 S_WOP
    s_add_u32 s93, s93, 2
    s_cmp_lt_u32 s93, 9
    s_cbranch_scc1 S_WOL
    s_waitcnt vmcnt(0)
    s_mov_b64 exec, 1
    ds_add_u32 v2, v3 offset:140
    s_mov_b64 exec, -1
    s_lshl_b32 s81, s78, 7
    s_add_u32 s81, s81, 8328192
    s_mov_b32 s83, 0x20000
    s_mov_b64 exec, 1
YL_83:
    buffer_load_dword v4, v2, s[68:71], s81 offen sc1
    s_waitcnt vmcnt(0)
    v_readfirstlane_b32 s80, v4
    s_cmp_eq_u32 s80, 1
    s_cbranch_scc1 YD_84
    s_sub_u32 s83, s83, 1
    s_cmp_eq_u32 s83, 0
    s_cbranch_scc1 YD_84
    s_sleep 8
    s_branch YL_83
YD_84:
    s_mov_b64 exec, -1
    v_mul_u32_u24 v6, 7282, v1
    v_lshrrev_b32 v6, 16, v6
    v_mul_u32_u24 v7, 9, v6
    v_sub_u32 v7, v1, v7
    v_lshlrev_b32 v4, 15, v7
    v_lshl_add_u32 v4, v6, 4, v4
    v_mul_u32_u24 v5, 18432, v6
    v_lshl_add_u32 v5, v7, 4, v5
    s_mul_i32 s81, s78, 294912
    s_lshl_b32 s82, s77, 7
    s_add_u32 s81, s81, s82
    s_lshl_b32 s82, s51, 6
    s_add_u32 s81, s81, s82
    s_add_u32 s81, s81, 5046272
    s_lshl_b32 s82, s77, 1
    s_add_u32 s82, s82, s51
    s_mul_i32 s82, s82, 73728
    s_mul_i32 s80, s78, 144
    s_add_u32 s82, s82, s80
    s_mov_b32 exec_lo, -1
    s_mov_b32 exec_hi, 0xf
    buffer_load_dwordx4 v[16:19], v4, s[68:71], s81 offen sc1
    s_add_u32 s81, s81, 4096
    buffer_load_dwordx4 v[20:23], v4, s[68:71], s81 offen sc1
    s_add_u32 s81, s81, 4096
    buffer_load_dwordx4 v[24:27], v4, s[68:71], s81 offen sc1
    s_add_u32 s81, s81, 4096
    buffer_load_dwordx4 v[28:31], v4, s[68:71], s81 offen sc1
    s_add_u32 s81, s81, 4096
    buffer_load_dwordx4 v[32:35], v4, s[68:71], s81 offen sc1
    s_add_u32 s81, s81, 4096
    buffer_load_dwordx4 v[36:39], v4, s[68:71], s81 offen sc1
    s_add_u32 s81, s81, 4096
    buffer_load_dwordx4 v[40:43], v4, s[68:71], s81 offen sc1
    s_add_u32 s81, s81, 4096
    buffer_load_dwordx4 v[44:47], v4, s[68:71], s81 offen sc1
    s_waitcnt vmcnt(0)
    v_perm_b32 v48, v20, v16, s94
    v_perm_b32 v49, v28, v24, s94
    v_perm_b32 v50, v36, v32, s94
    v_perm_b32 v51, v44, v40, s94
    v_perm_b32 v52, v20, v16, s95
    v_perm_b32 v53, v28, v24, s95
    v_perm_b32 v54, v36, v32, s95
    v_perm_b32 v55, v44, v40, s95
    v_perm_b32 v56, v21, v17, s94
    v_perm_b32 v57, v29, v25, s94
    v_perm_b32 v58, v37, v33, s94
    v_perm_b32 v59, v45, v41, s94
    v_perm_b32 v60, v21, v17, s95
    v_perm_b32 v61, v29, v25, s95
    v_perm_b32 v62, v37, v33, s95
    v_perm_b32 v63, v45, v41, s95
    v_perm_b32 v64, v22, v18, s94
    v_perm_b32 v65, v30, v26, s94
    v_perm_b32 v66, v38, v34, s94
    v_perm_b32 v67, v46, v42, s94
    v_perm_b32 v68, v22, v18, s95
    v_perm_b32 v69, v30, v26, s95
    v_perm_b32 v70, v38, v34, s95
    v_perm_b32 v71, v46, v42, s95
    v_perm_b32 v72, v23, v19, s94
    v_perm_b32 v73, v31, v27, s94
    v_perm_b32 v74, v39, v35, s94
    v_perm_b32 v75, v47, v43, s94
    v_perm_b32 v76, v23, v19, s95
    v_perm_b32 v77, v31, v27, s95
    v_perm_b32 v78, v39, v35, s95
    v_perm_b32 v79, v47, v43, s95
    buffer_store_dwordx4 v[48:51], v5, s[56:59], s82 offen sc1
    s_add_u32 s82, s82, 2304
    buffer_store_dwordx4 v[52:55], v5, s[56:59], s82 offen sc1
    s_add_u32 s82, s82, 2304
    buffer_store_dwordx4 v[56:59], v5, s[56:59], s82 offen sc1
    s_add_u32 s82, s82, 2304
    buffer_store_dwordx4 v[60:63], v5, s[56:59], s82 offen sc1
    s_add_u32 s82, s82, 2304
    buffer_store_dwordx4 v[64:67], v5, s[56:59], s82 offen sc1
    s_add_u32 s82, s82, 2304
    buffer_store_dwordx4 v[68:71], v5, s[56:59], s82 offen sc1
    s_add_u32 s82, s82, 2304
    buffer_store_dwordx4 v[72:75], v5, s[56:59], s82 offen sc1
    s_add_u32 s82, s82, 2304
    buffer_store_dwordx4 v[76:79], v5, s[56:59], s82 offen sc1
    s_mov_b64 exec, -1
S_TAIL:
    s_endpgm
MAIN_END:
    s_endpgm
.section .rodata,"a"
.p2align 6
.amdhsa_kernel concat_heads__ssm_conv_s4__grouped_kv_mqa__prompt_kernel
  .amdhsa_next_free_vgpr 168
  .amdhsa_next_free_sgpr 100
  .amdhsa_accum_offset 168
  .amdhsa_group_segment_fixed_size 0
  .amdhsa_kernarg_size 136
  .amdhsa_user_sgpr_count 2
  .amdhsa_user_sgpr_kernarg_segment_ptr 1
  .amdhsa_system_sgpr_workgroup_id_x 1
.end_amdhsa_kernel
```
